```python
import torch

def _softmax(x, axis=-1):
    return torch.softmax(x, dim=axis)

def _gelu(x):
    return torch.nn.functional.gelu(x, approximate='tanh')

def _silu(x):
    return torch.nn.functional.silu(x)

def _sigmoid(x):
    return torch.sigmoid(x)

def _layernorm(x, axis=-1, eps=1e-05):
    m = x.mean(dim=axis, keepdim=True)
    v = x.var(dim=axis, keepdim=True, unbiased=False)
    return (x - m) / torch.sqrt(v + eps)

def _scatter_add(tgt, idx, src, axis=0):
    return tgt.clone().index_add_(axis, idx, src)

def _segment_sum(src, seg, n):
    out = torch.zeros((n,) + src.shape[1:], dtype=src.dtype)
    return out.index_add_(0, seg, src)

def _pad(x, pw):
    flat = tuple((v for pair in reversed(pw) for v in pair))
    return torch.nn.functional.pad(x, flat)
kernel_name = 'sequential_preLN__memory_aug_recurrent_mem_tr__mixer_channel_mlp__prompt'

def setup_inputs():

    _w = lambda a: (lambda t: t.to(torch.bfloat16) if t.is_floating_point() else t)(torch.as_tensor(a))

    def _A_setup():
        B, S, Dm = (1, 2048, 640)
        H, Dh = (32, 192)
        M, seg = (8, 32)
        seg = min(seg, S)
        S = S // seg * seg
        return {'x': _w((lambda *s: torch.randn(*s, dtype=torch.bfloat16) * 0.05)(B, S, Dm)), 'mem0': _w((lambda *s: torch.randn(*s, dtype=torch.bfloat16) * 0.2)(B, M, Dm)), 'Wq': _w((lambda *s: torch.randn(*s, dtype=torch.bfloat16) * 1.6)(Dm, H, Dh) * Dm ** (-0.5)), 'Wk': _w((lambda *s: torch.randn(*s, dtype=torch.bfloat16) * 1.6)(Dm, H, Dh) * Dm ** (-0.5)), 'Wv': _w((lambda *s: torch.randn(*s, dtype=torch.bfloat16) * 0.2)(Dm, H, Dh) * Dm ** (-0.5)), 'Wo': _w((lambda *s: torch.randn(*s, dtype=torch.bfloat16) * 0.2)(H, Dh, Dm) * (H * Dh) ** (-0.5)), 'seg_len': seg}
    _A_in = _A_setup()

    def _B_setup():
        B, S, D, F = (1, 2048, 640, 1536)
        return {'x': _w((lambda *s: torch.randn(*s, dtype=torch.bfloat16) * 0.05)(B, S, D)), 'w1': _w((lambda *s: torch.randn(*s, dtype=torch.bfloat16) * 0.8)(D, F) * D ** (-0.5)), 'b1': _w((lambda *s: torch.randn(*s, dtype=torch.bfloat16) * 0.4)(F)), 'w2': _w((lambda *s: torch.randn(*s, dtype=torch.bfloat16) * 0.05)(F, D) * F ** (-0.5)), 'b2': _w((lambda *s: torch.randn(*s, dtype=torch.bfloat16) * 0.05)(D))}
    _B_in = _B_setup()
    return {'A_x': _A_in['x'], 'A_mem0': _A_in['mem0'], 'A_Wq': _A_in['Wq'], 'A_Wk': _A_in['Wk'], 'A_Wv': _A_in['Wv'], 'A_Wo': _A_in['Wo'], 'A_seg_len': _A_in['seg_len'], 'B_x': _B_in['x'], 'B_w1': _B_in['w1'], 'B_b1': _B_in['b1'], 'B_w2': _B_in['w2'], 'B_b2': _B_in['b2']}

def reference(A_x, A_mem0, A_Wq, A_Wk, A_Wv, A_Wo, A_seg_len, B_x, B_w1, B_b1, B_w2, B_b2):

    def _A_ref(x, mem0, Wq, Wk, Wv, Wo, seg_len):
        B, S, Dm = x.shape
        H, Dh = (Wq.shape[1], Wq.shape[2])
        M = mem0.shape[1]
        scale = Dh ** (-0.5)
        n_seg = S // seg_len
        L = M + seg_len
        idx = torch.arange(L)
        mask = (idx[:, None] < M) | (idx[:, None] >= idx[None, :])
        mem = mem0
        outs = []
        for s in range(n_seg):
            xs = x[:, s * seg_len:(s + 1) * seg_len, :].clone()
            h = torch.concatenate([mem, xs], axis=1)
            q = torch.einsum('btd,dhe->bhte', h, Wq)
            k = torch.einsum('btd,dhe->bhte', h, Wk)
            v = torch.einsum('btd,dhe->bhte', h, Wv)
            scores = torch.einsum('bhqe,bhke->bhqk', q, k) * scale
            scores = torch.where(mask[None, None], scores, -1000000000.0)
            p = _softmax(scores, axis=-1)
            o = torch.einsum('bhqk,bhke->bhqe', p, v)
            o = torch.einsum('bhte,hed->btd', o, Wo)
            mem = o[:, :M, :].clone()
            outs.append(o[:, M:, :])
        return torch.concatenate(outs, axis=1)

    def _B_ref(x, w1, b1, w2, b2):
        y = _layernorm(x, axis=-1)
        h = _gelu(torch.einsum('bsd,df->bsf', y, w1) + b1)
        return torch.einsum('bsf,fd->bsd', h, w2) + b2
    x = A_x
    h = x + _A_ref(_layernorm(x, axis=-1), A_mem0, A_Wq, A_Wk, A_Wv, A_Wo, A_seg_len)
    h2 = h + _B_ref(_layernorm(h, axis=-1), B_w1, B_b1, B_w2, B_b2)
    return h2
```

```asm
; @launch kernel=clr_kernel grid=(693,1,1) block=(256,1,1) lds=0
; @launch kernel=ln1_kernel grid=(512,1,1) block=(256,1,1) lds=0
; @launch kernel=tq_kernel grid=(240,1,1) block=(256,1,1) lds=0
; @launch kernel=tk_kernel grid=(240,1,1) block=(256,1,1) lds=0
; @launch kernel=tv_kernel grid=(240,1,1) block=(256,1,1) lds=0
; @launch kernel=to_kernel grid=(240,1,1) block=(256,1,1) lds=0
; @launch kernel=t1_kernel grid=(60,1,1) block=(256,1,1) lds=0
; @launch kernel=t2_kernel grid=(60,1,1) block=(256,1,1) lds=0
; @launch kernel=g1_kernel grid=(2304,1,1) block=(256,1,1) lds=36864
; @launch kernel=ch_kernel grid=(128,1,1) block=(256,1,1) lds=36864
; @launch kernel=at_kernel grid=(512,1,1) block=(256,1,1) lds=0
; @launch kernel=g2_kernel grid=(320,1,1) block=(256,1,1) lds=18432
; @launch kernel=ln2_kernel grid=(512,1,1) block=(256,1,1) lds=0
; @launch kernel=g3_kernel grid=(768,1,1) block=(256,1,1) lds=18432
; @launch kernel=g4_kernel grid=(320,1,1) block=(256,1,1) lds=18432
.amdgcn_target "amdgcn-amd-amdhsa--gfx950"
.text
.p2align 8
clr_kernel:
s_cmp_ge_u32 s2, 693
s_cbranch_scc1 clr_kernel_e
s_load_dwordx2 s[90:91], s[0:1], 112
s_waitcnt lgkmcnt(0)
s_add_u32 s8, s90, 162791424
s_addc_u32 s9, s91, 0
s_mov_b32 s10, 2838528
s_mov_b32 s11, 0x00020000
s_lshl_b32 s3, s2, 8
v_add_u32 v1, s3, v0
v_lshlrev_b32 v1, 4, v1
v_mov_b32 v4, 63
v_mov_b32 v5, 63
v_mov_b32 v6, 63
v_mov_b32 v7, 63
buffer_store_dwordx4 v[4:7], v1, s[8:11], 0 offen
clr_kernel_e:
s_endpgm
.p2align 8
ln1_kernel:
s_cmp_ge_u32 s2, 512
s_cbranch_scc1 ln1_kernel_e
s_load_dwordx2 s[90:91], s[0:1], 0
s_waitcnt lgkmcnt(0)
s_add_u32 s8, s90, 0
s_addc_u32 s9, s91, 0
s_mov_b32 s10, 2621440
s_mov_b32 s11, 0x00020000
s_load_dwordx2 s[90:91], s[0:1], 112
s_waitcnt lgkmcnt(0)
s_add_u32 s12, s90, 0
s_addc_u32 s13, s91, 0
s_mov_b32 s14, 2621440
s_mov_b32 s15, 0x00020000
v_lshrrev_b32 v1, 6, v0
v_and_b32 v2, 63, v0
s_lshl_b32 s3, s2, 2
v_add_u32 v1, s3, v1
v_mul_u32_u24 v1, 1280, v1
v_lshl_add_u32 v1, v2, 2, v1
buffer_load_dword v30, v1, s[8:11], 0 offen offset:0
buffer_load_dword v31, v1, s[8:11], 0 offen offset:256
buffer_load_dword v32, v1, s[8:11], 0 offen offset:512
buffer_load_dword v33, v1, s[8:11], 0 offen offset:768
buffer_load_dword v34, v1, s[8:11], 0 offen offset:1024
s_waitcnt vmcnt(0)
v_lshlrev_b32 v10, 16, v30
v_and_b32 v11, 0xffff0000, v30
v_lshlrev_b32 v12, 16, v31
v_and_b32 v13, 0xffff0000, v31
v_lshlrev_b32 v14, 16, v32
v_and_b32 v15, 0xffff0000, v32
v_lshlrev_b32 v16, 16, v33
v_and_b32 v17, 0xffff0000, v33
v_lshlrev_b32 v18, 16, v34
v_and_b32 v19, 0xffff0000, v34
v_mov_b32 v20, 0
v_add_f32 v20, v20, v10
v_add_f32 v20, v20, v11
v_add_f32 v20, v20, v12
v_add_f32 v20, v20, v13
v_add_f32 v20, v20, v14
v_add_f32 v20, v20, v15
v_add_f32 v20, v20, v16
v_add_f32 v20, v20, v17
v_add_f32 v20, v20, v18
v_add_f32 v20, v20, v19
ds_swizzle_b32 v21, v20 offset:0x41f
s_waitcnt lgkmcnt(0)
v_add_f32 v20, v20, v21
ds_swizzle_b32 v21, v20 offset:0x81f
s_waitcnt lgkmcnt(0)
v_add_f32 v20, v20, v21
ds_swizzle_b32 v21, v20 offset:0x101f
s_waitcnt lgkmcnt(0)
v_add_f32 v20, v20, v21
ds_swizzle_b32 v21, v20 offset:0x201f
s_waitcnt lgkmcnt(0)
v_add_f32 v20, v20, v21
ds_swizzle_b32 v21, v20 offset:0x401f
s_waitcnt lgkmcnt(0)
v_add_f32 v20, v20, v21
s_nop 1
v_readlane_b32 s80, v20, 0
v_readlane_b32 s81, v20, 32
s_nop 3
v_mov_b32 v20, s80
v_add_f32 v20, s81, v20
v_mul_f32 v20, 0x3acccccd, v20
v_mov_b32 v22, 0
v_sub_f32 v23, v10, v20
v_fmac_f32 v22, v23, v23
v_sub_f32 v23, v11, v20
v_fmac_f32 v22, v23, v23
v_sub_f32 v23, v12, v20
v_fmac_f32 v22, v23, v23
v_sub_f32 v23, v13, v20
v_fmac_f32 v22, v23, v23
v_sub_f32 v23, v14, v20
v_fmac_f32 v22, v23, v23
v_sub_f32 v23, v15, v20
v_fmac_f32 v22, v23, v23
v_sub_f32 v23, v16, v20
v_fmac_f32 v22, v23, v23
v_sub_f32 v23, v17, v20
v_fmac_f32 v22, v23, v23
v_sub_f32 v23, v18, v20
v_fmac_f32 v22, v23, v23
v_sub_f32 v23, v19, v20
v_fmac_f32 v22, v23, v23
ds_swizzle_b32 v21, v22 offset:0x41f
s_waitcnt lgkmcnt(0)
v_add_f32 v22, v22, v21
ds_swizzle_b32 v21, v22 offset:0x81f
s_waitcnt lgkmcnt(0)
v_add_f32 v22, v22, v21
ds_swizzle_b32 v21, v22 offset:0x101f
s_waitcnt lgkmcnt(0)
v_add_f32 v22, v22, v21
ds_swizzle_b32 v21, v22 offset:0x201f
s_waitcnt lgkmcnt(0)
v_add_f32 v22, v22, v21
ds_swizzle_b32 v21, v22 offset:0x401f
s_waitcnt lgkmcnt(0)
v_add_f32 v22, v22, v21
s_nop 1
v_readlane_b32 s80, v22, 0
v_readlane_b32 s81, v22, 32
s_nop 3
v_mov_b32 v22, s80
v_add_f32 v22, s81, v22
v_mul_f32 v22, 0x3acccccd, v22
v_cvt_pk_bf16_f32 v21, v20, v20
v_lshlrev_b32 v20, 16, v21
v_cvt_pk_bf16_f32 v21, v22, v22
v_lshlrev_b32 v22, 16, v21
v_add_f32 v22, 0x3727c5ac, v22
v_cvt_pk_bf16_f32 v21, v22, v22
v_lshlrev_b32 v22, 16, v21
v_sqrt_f32 v22, v22
s_nop 0
v_cvt_pk_bf16_f32 v21, v22, v22
v_lshlrev_b32 v22, 16, v21
v_rcp_f32 v22, v22
s_nop 0
v_sub_f32 v10, v10, v20
v_cvt_pk_bf16_f32 v21, v10, v10
v_lshlrev_b32 v10, 16, v21
v_mul_f32 v10, v10, v22
v_cvt_pk_bf16_f32 v21, v10, v10
v_lshlrev_b32 v10, 16, v21
v_sub_f32 v11, v11, v20
v_cvt_pk_bf16_f32 v21, v11, v11
v_lshlrev_b32 v11, 16, v21
v_mul_f32 v11, v11, v22
v_cvt_pk_bf16_f32 v21, v11, v11
v_lshlrev_b32 v11, 16, v21
v_sub_f32 v12, v12, v20
v_cvt_pk_bf16_f32 v21, v12, v12
v_lshlrev_b32 v12, 16, v21
v_mul_f32 v12, v12, v22
v_cvt_pk_bf16_f32 v21, v12, v12
v_lshlrev_b32 v12, 16, v21
v_sub_f32 v13, v13, v20
v_cvt_pk_bf16_f32 v21, v13, v13
v_lshlrev_b32 v13, 16, v21
v_mul_f32 v13, v13, v22
v_cvt_pk_bf16_f32 v21, v13, v13
v_lshlrev_b32 v13, 16, v21
v_sub_f32 v14, v14, v20
v_cvt_pk_bf16_f32 v21, v14, v14
v_lshlrev_b32 v14, 16, v21
v_mul_f32 v14, v14, v22
v_cvt_pk_bf16_f32 v21, v14, v14
v_lshlrev_b32 v14, 16, v21
v_sub_f32 v15, v15, v20
v_cvt_pk_bf16_f32 v21, v15, v15
v_lshlrev_b32 v15, 16, v21
v_mul_f32 v15, v15, v22
v_cvt_pk_bf16_f32 v21, v15, v15
v_lshlrev_b32 v15, 16, v21
v_sub_f32 v16, v16, v20
v_cvt_pk_bf16_f32 v21, v16, v16
v_lshlrev_b32 v16, 16, v21
v_mul_f32 v16, v16, v22
v_cvt_pk_bf16_f32 v21, v16, v16
v_lshlrev_b32 v16, 16, v21
v_sub_f32 v17, v17, v20
v_cvt_pk_bf16_f32 v21, v17, v17
v_lshlrev_b32 v17, 16, v21
v_mul_f32 v17, v17, v22
v_cvt_pk_bf16_f32 v21, v17, v17
v_lshlrev_b32 v17, 16, v21
v_sub_f32 v18, v18, v20
v_cvt_pk_bf16_f32 v21, v18, v18
v_lshlrev_b32 v18, 16, v21
v_mul_f32 v18, v18, v22
v_cvt_pk_bf16_f32 v21, v18, v18
v_lshlrev_b32 v18, 16, v21
v_sub_f32 v19, v19, v20
v_cvt_pk_bf16_f32 v21, v19, v19
v_lshlrev_b32 v19, 16, v21
v_mul_f32 v19, v19, v22
v_cvt_pk_bf16_f32 v21, v19, v19
v_lshlrev_b32 v19, 16, v21
v_cvt_pk_bf16_f32 v30, v10, v11
buffer_store_dword v30, v1, s[12:15], 0 offen offset:0
v_cvt_pk_bf16_f32 v30, v12, v13
buffer_store_dword v30, v1, s[12:15], 0 offen offset:256
v_cvt_pk_bf16_f32 v30, v14, v15
buffer_store_dword v30, v1, s[12:15], 0 offen offset:512
v_cvt_pk_bf16_f32 v30, v16, v17
buffer_store_dword v30, v1, s[12:15], 0 offen offset:768
v_cvt_pk_bf16_f32 v30, v18, v19
buffer_store_dword v30, v1, s[12:15], 0 offen offset:1024
ln1_kernel_e:
s_endpgm
.p2align 8
tq_kernel:
s_cmp_ge_u32 s2, 240
s_cbranch_scc1 tq_kernel_e
s_load_dwordx2 s[90:91], s[0:1], 16
s_waitcnt lgkmcnt(0)
s_add_u32 s8, s90, 0
s_addc_u32 s9, s91, 0
s_mov_b32 s10, 7864320
s_mov_b32 s11, 0x00020000
s_load_dwordx2 s[90:91], s[0:1], 112
s_waitcnt lgkmcnt(0)
s_add_u32 s12, s90, 2621440
s_addc_u32 s13, s91, 0
s_mov_b32 s14, 7864320
s_mov_b32 s15, 0x00020000
s_lshl_b32 s3, s2, 8
v_add_u32 v1, s3, v0
s_mov_b32 s4, 5592406
v_mul_hi_u32 v2, v1, s4
s_mov_b32 s5, 768
v_mul_lo_u32 v3, v2, s5
v_sub_u32 v3, v1, v3
s_mov_b32 s6, 98304
v_mul_lo_u32 v4, v2, s6
v_lshl_add_u32 v4, v3, 4, v4
v_add_u32 v5, 0, v4
buffer_load_dwordx4 v[8:11], v5, s[8:11], 0 offen
v_add_u32 v5, 12288, v4
buffer_load_dwordx4 v[12:15], v5, s[8:11], 0 offen
v_add_u32 v5, 24576, v4
buffer_load_dwordx4 v[16:19], v5, s[8:11], 0 offen
v_add_u32 v5, 36864, v4
buffer_load_dwordx4 v[20:23], v5, s[8:11], 0 offen
v_add_u32 v5, 49152, v4
buffer_load_dwordx4 v[24:27], v5, s[8:11], 0 offen
v_add_u32 v5, 61440, v4
buffer_load_dwordx4 v[28:31], v5, s[8:11], 0 offen
v_add_u32 v5, 73728, v4
buffer_load_dwordx4 v[32:35], v5, s[8:11], 0 offen
v_add_u32 v5, 86016, v4
buffer_load_dwordx4 v[36:39], v5, s[8:11], 0 offen
s_mov_b32 s6, 10240
v_mul_lo_u32 v4, v3, s6
v_lshl_add_u32 v4, v2, 4, v4
s_mov_b32 s20, 0x05040100
s_mov_b32 s21, 0x07060302
s_waitcnt vmcnt(0)
v_perm_b32 v48, v12, v8, s20
v_perm_b32 v49, v20, v16, s20
v_perm_b32 v50, v28, v24, s20
v_perm_b32 v51, v36, v32, s20
v_add_u32 v5, 0, v4
buffer_store_dwordx4 v[48:51], v5, s[12:15], 0 offen
s_nop 1
v_perm_b32 v48, v12, v8, s21
v_perm_b32 v49, v20, v16, s21
v_perm_b32 v50, v28, v24, s21
v_perm_b32 v51, v36, v32, s21
v_add_u32 v5, 1280, v4
buffer_store_dwordx4 v[48:51], v5, s[12:15], 0 offen
s_nop 1
v_perm_b32 v48, v13, v9, s20
v_perm_b32 v49, v21, v17, s20
v_perm_b32 v50, v29, v25, s20
v_perm_b32 v51, v37, v33, s20
v_add_u32 v5, 2560, v4
buffer_store_dwordx4 v[48:51], v5, s[12:15], 0 offen
s_nop 1
v_perm_b32 v48, v13, v9, s21
v_perm_b32 v49, v21, v17, s21
v_perm_b32 v50, v29, v25, s21
v_perm_b32 v51, v37, v33, s21
v_add_u32 v5, 3840, v4
buffer_store_dwordx4 v[48:51], v5, s[12:15], 0 offen
s_nop 1
v_perm_b32 v48, v14, v10, s20
v_perm_b32 v49, v22, v18, s20
v_perm_b32 v50, v30, v26, s20
v_perm_b32 v51, v38, v34, s20
v_add_u32 v5, 5120, v4
buffer_store_dwordx4 v[48:51], v5, s[12:15], 0 offen
s_nop 1
v_perm_b32 v48, v14, v10, s21
v_perm_b32 v49, v22, v18, s21
v_perm_b32 v50, v30, v26, s21
v_perm_b32 v51, v38, v34, s21
v_add_u32 v5, 6400, v4
buffer_store_dwordx4 v[48:51], v5, s[12:15], 0 offen
s_nop 1
v_perm_b32 v48, v15, v11, s20
v_perm_b32 v49, v23, v19, s20
v_perm_b32 v50, v31, v27, s20
v_perm_b32 v51, v39, v35, s20
v_add_u32 v5, 7680, v4
buffer_store_dwordx4 v[48:51], v5, s[12:15], 0 offen
s_nop 1
v_perm_b32 v48, v15, v11, s21
v_perm_b32 v49, v23, v19, s21
v_perm_b32 v50, v31, v27, s21
v_perm_b32 v51, v39, v35, s21
v_add_u32 v5, 8960, v4
buffer_store_dwordx4 v[48:51], v5, s[12:15], 0 offen
s_nop 1
tq_kernel_e:
s_endpgm
.p2align 8
tk_kernel:
s_cmp_ge_u32 s2, 240
s_cbranch_scc1 tk_kernel_e
s_load_dwordx2 s[90:91], s[0:1], 24
s_waitcnt lgkmcnt(0)
s_add_u32 s8, s90, 0
s_addc_u32 s9, s91, 0
s_mov_b32 s10, 7864320
s_mov_b32 s11, 0x00020000
s_load_dwordx2 s[90:91], s[0:1], 112
s_waitcnt lgkmcnt(0)
s_add_u32 s12, s90, 10485760
s_addc_u32 s13, s91, 0
s_mov_b32 s14, 7864320
s_mov_b32 s15, 0x00020000
s_lshl_b32 s3, s2, 8
v_add_u32 v1, s3, v0
s_mov_b32 s4, 5592406
v_mul_hi_u32 v2, v1, s4
s_mov_b32 s5, 768
v_mul_lo_u32 v3, v2, s5
v_sub_u32 v3, v1, v3
s_mov_b32 s6, 98304
v_mul_lo_u32 v4, v2, s6
v_lshl_add_u32 v4, v3, 4, v4
v_add_u32 v5, 0, v4
buffer_load_dwordx4 v[8:11], v5, s[8:11], 0 offen
v_add_u32 v5, 12288, v4
buffer_load_dwordx4 v[12:15], v5, s[8:11], 0 offen
v_add_u32 v5, 24576, v4
buffer_load_dwordx4 v[16:19], v5, s[8:11], 0 offen
v_add_u32 v5, 36864, v4
buffer_load_dwordx4 v[20:23], v5, s[8:11], 0 offen
v_add_u32 v5, 49152, v4
buffer_load_dwordx4 v[24:27], v5, s[8:11], 0 offen
v_add_u32 v5, 61440, v4
buffer_load_dwordx4 v[28:31], v5, s[8:11], 0 offen
v_add_u32 v5, 73728, v4
buffer_load_dwordx4 v[32:35], v5, s[8:11], 0 offen
v_add_u32 v5, 86016, v4
buffer_load_dwordx4 v[36:39], v5, s[8:11], 0 offen
s_mov_b32 s6, 10240
v_mul_lo_u32 v4, v3, s6
v_lshl_add_u32 v4, v2, 4, v4
s_mov_b32 s20, 0x05040100
s_mov_b32 s21, 0x07060302
s_waitcnt vmcnt(0)
v_perm_b32 v48, v12, v8, s20
v_perm_b32 v49, v20, v16, s20
v_perm_b32 v50, v28, v24, s20
v_perm_b32 v51, v36, v32, s20
v_add_u32 v5, 0, v4
buffer_store_dwordx4 v[48:51], v5, s[12:15], 0 offen
s_nop 1
v_perm_b32 v48, v12, v8, s21
v_perm_b32 v49, v20, v16, s21
v_perm_b32 v50, v28, v24, s21
v_perm_b32 v51, v36, v32, s21
v_add_u32 v5, 1280, v4
buffer_store_dwordx4 v[48:51], v5, s[12:15], 0 offen
s_nop 1
v_perm_b32 v48, v13, v9, s20
v_perm_b32 v49, v21, v17, s20
v_perm_b32 v50, v29, v25, s20
v_perm_b32 v51, v37, v33, s20
v_add_u32 v5, 2560, v4
buffer_store_dwordx4 v[48:51], v5, s[12:15], 0 offen
s_nop 1
v_perm_b32 v48, v13, v9, s21
v_perm_b32 v49, v21, v17, s21
v_perm_b32 v50, v29, v25, s21
v_perm_b32 v51, v37, v33, s21
v_add_u32 v5, 3840, v4
buffer_store_dwordx4 v[48:51], v5, s[12:15], 0 offen
s_nop 1
v_perm_b32 v48, v14, v10, s20
v_perm_b32 v49, v22, v18, s20
v_perm_b32 v50, v30, v26, s20
v_perm_b32 v51, v38, v34, s20
v_add_u32 v5, 5120, v4
buffer_store_dwordx4 v[48:51], v5, s[12:15], 0 offen
s_nop 1
v_perm_b32 v48, v14, v10, s21
v_perm_b32 v49, v22, v18, s21
v_perm_b32 v50, v30, v26, s21
v_perm_b32 v51, v38, v34, s21
v_add_u32 v5, 6400, v4
buffer_store_dwordx4 v[48:51], v5, s[12:15], 0 offen
s_nop 1
v_perm_b32 v48, v15, v11, s20
v_perm_b32 v49, v23, v19, s20
v_perm_b32 v50, v31, v27, s20
v_perm_b32 v51, v39, v35, s20
v_add_u32 v5, 7680, v4
buffer_store_dwordx4 v[48:51], v5, s[12:15], 0 offen
s_nop 1
v_perm_b32 v48, v15, v11, s21
v_perm_b32 v49, v23, v19, s21
v_perm_b32 v50, v31, v27, s21
v_perm_b32 v51, v39, v35, s21
v_add_u32 v5, 8960, v4
buffer_store_dwordx4 v[48:51], v5, s[12:15], 0 offen
s_nop 1
tk_kernel_e:
s_endpgm
.p2align 8
tv_kernel:
s_cmp_ge_u32 s2, 240
s_cbranch_scc1 tv_kernel_e
s_load_dwordx2 s[90:91], s[0:1], 32
s_waitcnt lgkmcnt(0)
s_add_u32 s8, s90, 0
s_addc_u32 s9, s91, 0
s_mov_b32 s10, 7864320
s_mov_b32 s11, 0x00020000
s_load_dwordx2 s[90:91], s[0:1], 112
s_waitcnt lgkmcnt(0)
s_add_u32 s12, s90, 18350080
s_addc_u32 s13, s91, 0
s_mov_b32 s14, 7864320
s_mov_b32 s15, 0x00020000
s_lshl_b32 s3, s2, 8
v_add_u32 v1, s3, v0
s_mov_b32 s4, 5592406
v_mul_hi_u32 v2, v1, s4
s_mov_b32 s5, 768
v_mul_lo_u32 v3, v2, s5
v_sub_u32 v3, v1, v3
s_mov_b32 s6, 98304
v_mul_lo_u32 v4, v2, s6
v_lshl_add_u32 v4, v3, 4, v4
v_add_u32 v5, 0, v4
buffer_load_dwordx4 v[8:11], v5, s[8:11], 0 offen
v_add_u32 v5, 12288, v4
buffer_load_dwordx4 v[12:15], v5, s[8:11], 0 offen
v_add_u32 v5, 24576, v4
buffer_load_dwordx4 v[16:19], v5, s[8:11], 0 offen
v_add_u32 v5, 36864, v4
buffer_load_dwordx4 v[20:23], v5, s[8:11], 0 offen
v_add_u32 v5, 49152, v4
buffer_load_dwordx4 v[24:27], v5, s[8:11], 0 offen
v_add_u32 v5, 61440, v4
buffer_load_dwordx4 v[28:31], v5, s[8:11], 0 offen
v_add_u32 v5, 73728, v4
buffer_load_dwordx4 v[32:35], v5, s[8:11], 0 offen
v_add_u32 v5, 86016, v4
buffer_load_dwordx4 v[36:39], v5, s[8:11], 0 offen
s_mov_b32 s6, 10240
v_mul_lo_u32 v4, v3, s6
v_lshl_add_u32 v4, v2, 4, v4
s_mov_b32 s20, 0x05040100
s_mov_b32 s21, 0x07060302
s_waitcnt vmcnt(0)
v_perm_b32 v48, v12, v8, s20
v_perm_b32 v49, v20, v16, s20
v_perm_b32 v50, v28, v24, s20
v_perm_b32 v51, v36, v32, s20
v_add_u32 v5, 0, v4
buffer_store_dwordx4 v[48:51], v5, s[12:15], 0 offen
s_nop 1
v_perm_b32 v48, v12, v8, s21
v_perm_b32 v49, v20, v16, s21
v_perm_b32 v50, v28, v24, s21
v_perm_b32 v51, v36, v32, s21
v_add_u32 v5, 1280, v4
buffer_store_dwordx4 v[48:51], v5, s[12:15], 0 offen
s_nop 1
v_perm_b32 v48, v13, v9, s20
v_perm_b32 v49, v21, v17, s20
v_perm_b32 v50, v29, v25, s20
v_perm_b32 v51, v37, v33, s20
v_add_u32 v5, 2560, v4
buffer_store_dwordx4 v[48:51], v5, s[12:15], 0 offen
s_nop 1
v_perm_b32 v48, v13, v9, s21
v_perm_b32 v49, v21, v17, s21
v_perm_b32 v50, v29, v25, s21
v_perm_b32 v51, v37, v33, s21
v_add_u32 v5, 3840, v4
buffer_store_dwordx4 v[48:51], v5, s[12:15], 0 offen
s_nop 1
v_perm_b32 v48, v14, v10, s20
v_perm_b32 v49, v22, v18, s20
v_perm_b32 v50, v30, v26, s20
v_perm_b32 v51, v38, v34, s20
v_add_u32 v5, 5120, v4
buffer_store_dwordx4 v[48:51], v5, s[12:15], 0 offen
s_nop 1
v_perm_b32 v48, v14, v10, s21
v_perm_b32 v49, v22, v18, s21
v_perm_b32 v50, v30, v26, s21
v_perm_b32 v51, v38, v34, s21
v_add_u32 v5, 6400, v4
buffer_store_dwordx4 v[48:51], v5, s[12:15], 0 offen
s_nop 1
v_perm_b32 v48, v15, v11, s20
v_perm_b32 v49, v23, v19, s20
v_perm_b32 v50, v31, v27, s20
v_perm_b32 v51, v39, v35, s20
v_add_u32 v5, 7680, v4
buffer_store_dwordx4 v[48:51], v5, s[12:15], 0 offen
s_nop 1
v_perm_b32 v48, v15, v11, s21
v_perm_b32 v49, v23, v19, s21
v_perm_b32 v50, v31, v27, s21
v_perm_b32 v51, v39, v35, s21
v_add_u32 v5, 8960, v4
buffer_store_dwordx4 v[48:51], v5, s[12:15], 0 offen
s_nop 1
tv_kernel_e:
s_endpgm
.p2align 8
to_kernel:
s_cmp_ge_u32 s2, 240
s_cbranch_scc1 to_kernel_e
s_load_dwordx2 s[90:91], s[0:1], 40
s_waitcnt lgkmcnt(0)
s_add_u32 s8, s90, 0
s_addc_u32 s9, s91, 0
s_mov_b32 s10, 7864320
s_mov_b32 s11, 0x00020000
s_load_dwordx2 s[90:91], s[0:1], 112
s_waitcnt lgkmcnt(0)
s_add_u32 s12, s90, 26214400
s_addc_u32 s13, s91, 0
s_mov_b32 s14, 7864320
s_mov_b32 s15, 0x00020000
s_lshl_b32 s3, s2, 8
v_add_u32 v1, s3, v0
s_mov_b32 s4, 53687092
v_mul_hi_u32 v2, v1, s4
s_mov_b32 s5, 80
v_mul_lo_u32 v3, v2, s5
v_sub_u32 v3, v1, v3
s_mov_b32 s6, 10240
v_mul_lo_u32 v4, v2, s6
v_lshl_add_u32 v4, v3, 4, v4
v_add_u32 v5, 0, v4
buffer_load_dwordx4 v[8:11], v5, s[8:11], 0 offen
v_add_u32 v5, 1280, v4
buffer_load_dwordx4 v[12:15], v5, s[8:11], 0 offen
v_add_u32 v5, 2560, v4
buffer_load_dwordx4 v[16:19], v5, s[8:11], 0 offen
v_add_u32 v5, 3840, v4
buffer_load_dwordx4 v[20:23], v5, s[8:11], 0 offen
v_add_u32 v5, 5120, v4
buffer_load_dwordx4 v[24:27], v5, s[8:11], 0 offen
v_add_u32 v5, 6400, v4
buffer_load_dwordx4 v[28:31], v5, s[8:11], 0 offen
v_add_u32 v5, 7680, v4
buffer_load_dwordx4 v[32:35], v5, s[8:11], 0 offen
v_add_u32 v5, 8960, v4
buffer_load_dwordx4 v[36:39], v5, s[8:11], 0 offen
s_mov_b32 s6, 98304
v_mul_lo_u32 v4, v3, s6
v_lshl_add_u32 v4, v2, 4, v4
s_mov_b32 s20, 0x05040100
s_mov_b32 s21, 0x07060302
s_waitcnt vmcnt(0)
v_perm_b32 v48, v12, v8, s20
v_perm_b32 v49, v20, v16, s20
v_perm_b32 v50, v28, v24, s20
v_perm_b32 v51, v36, v32, s20
v_add_u32 v5, 0, v4
buffer_store_dwordx4 v[48:51], v5, s[12:15], 0 offen
s_nop 1
v_perm_b32 v48, v12, v8, s21
v_perm_b32 v49, v20, v16, s21
v_perm_b32 v50, v28, v24, s21
v_perm_b32 v51, v36, v32, s21
v_add_u32 v5, 12288, v4
buffer_store_dwordx4 v[48:51], v5, s[12:15], 0 offen
s_nop 1
v_perm_b32 v48, v13, v9, s20
v_perm_b32 v49, v21, v17, s20
v_perm_b32 v50, v29, v25, s20
v_perm_b32 v51, v37, v33, s20
v_add_u32 v5, 24576, v4
buffer_store_dwordx4 v[48:51], v5, s[12:15], 0 offen
s_nop 1
v_perm_b32 v48, v13, v9, s21
v_perm_b32 v49, v21, v17, s21
v_perm_b32 v50, v29, v25, s21
v_perm_b32 v51, v37, v33, s21
v_add_u32 v5, 36864, v4
buffer_store_dwordx4 v[48:51], v5, s[12:15], 0 offen
s_nop 1
v_perm_b32 v48, v14, v10, s20
v_perm_b32 v49, v22, v18, s20
v_perm_b32 v50, v30, v26, s20
v_perm_b32 v51, v38, v34, s20
v_add_u32 v5, 49152, v4
buffer_store_dwordx4 v[48:51], v5, s[12:15], 0 offen
s_nop 1
v_perm_b32 v48, v14, v10, s21
v_perm_b32 v49, v22, v18, s21
v_perm_b32 v50, v30, v26, s21
v_perm_b32 v51, v38, v34, s21
v_add_u32 v5, 61440, v4
buffer_store_dwordx4 v[48:51], v5, s[12:15], 0 offen
s_nop 1
v_perm_b32 v48, v15, v11, s20
v_perm_b32 v49, v23, v19, s20
v_perm_b32 v50, v31, v27, s20
v_perm_b32 v51, v39, v35, s20
v_add_u32 v5, 73728, v4
buffer_store_dwordx4 v[48:51], v5, s[12:15], 0 offen
s_nop 1
v_perm_b32 v48, v15, v11, s21
v_perm_b32 v49, v23, v19, s21
v_perm_b32 v50, v31, v27, s21
v_perm_b32 v51, v39, v35, s21
v_add_u32 v5, 86016, v4
buffer_store_dwordx4 v[48:51], v5, s[12:15], 0 offen
s_nop 1
to_kernel_e:
s_endpgm
.p2align 8
t1_kernel:
s_cmp_ge_u32 s2, 60
s_cbranch_scc1 t1_kernel_e
s_load_dwordx2 s[90:91], s[0:1], 64
s_waitcnt lgkmcnt(0)
s_add_u32 s8, s90, 0
s_addc_u32 s9, s91, 0
s_mov_b32 s10, 1966080
s_mov_b32 s11, 0x00020000
s_load_dwordx2 s[90:91], s[0:1], 112
s_waitcnt lgkmcnt(0)
s_add_u32 s12, s90, 34078720
s_addc_u32 s13, s91, 0
s_mov_b32 s14, 1966080
s_mov_b32 s15, 0x00020000
s_lshl_b32 s3, s2, 8
v_add_u32 v1, s3, v0
s_mov_b32 s4, 22369622
v_mul_hi_u32 v2, v1, s4
s_mov_b32 s5, 192
v_mul_lo_u32 v3, v2, s5
v_sub_u32 v3, v1, v3
s_mov_b32 s6, 24576
v_mul_lo_u32 v4, v2, s6
v_lshl_add_u32 v4, v3, 4, v4
v_add_u32 v5, 0, v4
buffer_load_dwordx4 v[8:11], v5, s[8:11], 0 offen
v_add_u32 v5, 3072, v4
buffer_load_dwordx4 v[12:15], v5, s[8:11], 0 offen
v_add_u32 v5, 6144, v4
buffer_load_dwordx4 v[16:19], v5, s[8:11], 0 offen
v_add_u32 v5, 9216, v4
buffer_load_dwordx4 v[20:23], v5, s[8:11], 0 offen
v_add_u32 v5, 12288, v4
buffer_load_dwordx4 v[24:27], v5, s[8:11], 0 offen
v_add_u32 v5, 15360, v4
buffer_load_dwordx4 v[28:31], v5, s[8:11], 0 offen
v_add_u32 v5, 18432, v4
buffer_load_dwordx4 v[32:35], v5, s[8:11], 0 offen
v_add_u32 v5, 21504, v4
buffer_load_dwordx4 v[36:39], v5, s[8:11], 0 offen
s_mov_b32 s6, 10240
v_mul_lo_u32 v4, v3, s6
v_lshl_add_u32 v4, v2, 4, v4
s_mov_b32 s20, 0x05040100
s_mov_b32 s21, 0x07060302
s_waitcnt vmcnt(0)
v_perm_b32 v48, v12, v8, s20
v_perm_b32 v49, v20, v16, s20
v_perm_b32 v50, v28, v24, s20
v_perm_b32 v51, v36, v32, s20
v_add_u32 v5, 0, v4
buffer_store_dwordx4 v[48:51], v5, s[12:15], 0 offen
s_nop 1
v_perm_b32 v48, v12, v8, s21
v_perm_b32 v49, v20, v16, s21
v_perm_b32 v50, v28, v24, s21
v_perm_b32 v51, v36, v32, s21
v_add_u32 v5, 1280, v4
buffer_store_dwordx4 v[48:51], v5, s[12:15], 0 offen
s_nop 1
v_perm_b32 v48, v13, v9, s20
v_perm_b32 v49, v21, v17, s20
v_perm_b32 v50, v29, v25, s20
v_perm_b32 v51, v37, v33, s20
v_add_u32 v5, 2560, v4
buffer_store_dwordx4 v[48:51], v5, s[12:15], 0 offen
s_nop 1
v_perm_b32 v48, v13, v9, s21
v_perm_b32 v49, v21, v17, s21
v_perm_b32 v50, v29, v25, s21
v_perm_b32 v51, v37, v33, s21
v_add_u32 v5, 3840, v4
buffer_store_dwordx4 v[48:51], v5, s[12:15], 0 offen
s_nop 1
v_perm_b32 v48, v14, v10, s20
v_perm_b32 v49, v22, v18, s20
v_perm_b32 v50, v30, v26, s20
v_perm_b32 v51, v38, v34, s20
v_add_u32 v5, 5120, v4
buffer_store_dwordx4 v[48:51], v5, s[12:15], 0 offen
s_nop 1
v_perm_b32 v48, v14, v10, s21
v_perm_b32 v49, v22, v18, s21
v_perm_b32 v50, v30, v26, s21
v_perm_b32 v51, v38, v34, s21
v_add_u32 v5, 6400, v4
buffer_store_dwordx4 v[48:51], v5, s[12:15], 0 offen
s_nop 1
v_perm_b32 v48, v15, v11, s20
v_perm_b32 v49, v23, v19, s20
v_perm_b32 v50, v31, v27, s20
v_perm_b32 v51, v39, v35, s20
v_add_u32 v5, 7680, v4
buffer_store_dwordx4 v[48:51], v5, s[12:15], 0 offen
s_nop 1
v_perm_b32 v48, v15, v11, s21
v_perm_b32 v49, v23, v19, s21
v_perm_b32 v50, v31, v27, s21
v_perm_b32 v51, v39, v35, s21
v_add_u32 v5, 8960, v4
buffer_store_dwordx4 v[48:51], v5, s[12:15], 0 offen
s_nop 1
t1_kernel_e:
s_endpgm
.p2align 8
t2_kernel:
s_cmp_ge_u32 s2, 60
s_cbranch_scc1 t2_kernel_e
s_load_dwordx2 s[90:91], s[0:1], 80
s_waitcnt lgkmcnt(0)
s_add_u32 s8, s90, 0
s_addc_u32 s9, s91, 0
s_mov_b32 s10, 1966080
s_mov_b32 s11, 0x00020000
s_load_dwordx2 s[90:91], s[0:1], 112
s_waitcnt lgkmcnt(0)
s_add_u32 s12, s90, 36044800
s_addc_u32 s13, s91, 0
s_mov_b32 s14, 1966080
s_mov_b32 s15, 0x00020000
s_lshl_b32 s3, s2, 8
v_add_u32 v1, s3, v0
s_mov_b32 s4, 53687092
v_mul_hi_u32 v2, v1, s4
s_mov_b32 s5, 80
v_mul_lo_u32 v3, v2, s5
v_sub_u32 v3, v1, v3
s_mov_b32 s6, 10240
v_mul_lo_u32 v4, v2, s6
v_lshl_add_u32 v4, v3, 4, v4
v_add_u32 v5, 0, v4
buffer_load_dwordx4 v[8:11], v5, s[8:11], 0 offen
v_add_u32 v5, 1280, v4
buffer_load_dwordx4 v[12:15], v5, s[8:11], 0 offen
v_add_u32 v5, 2560, v4
buffer_load_dwordx4 v[16:19], v5, s[8:11], 0 offen
v_add_u32 v5, 3840, v4
buffer_load_dwordx4 v[20:23], v5, s[8:11], 0 offen
v_add_u32 v5, 5120, v4
buffer_load_dwordx4 v[24:27], v5, s[8:11], 0 offen
v_add_u32 v5, 6400, v4
buffer_load_dwordx4 v[28:31], v5, s[8:11], 0 offen
v_add_u32 v5, 7680, v4
buffer_load_dwordx4 v[32:35], v5, s[8:11], 0 offen
v_add_u32 v5, 8960, v4
buffer_load_dwordx4 v[36:39], v5, s[8:11], 0 offen
s_mov_b32 s6, 24576
v_mul_lo_u32 v4, v3, s6
v_lshl_add_u32 v4, v2, 4, v4
s_mov_b32 s20, 0x05040100
s_mov_b32 s21, 0x07060302
s_waitcnt vmcnt(0)
v_perm_b32 v48, v12, v8, s20
v_perm_b32 v49, v20, v16, s20
v_perm_b32 v50, v28, v24, s20
v_perm_b32 v51, v36, v32, s20
v_add_u32 v5, 0, v4
buffer_store_dwordx4 v[48:51], v5, s[12:15], 0 offen
s_nop 1
v_perm_b32 v48, v12, v8, s21
v_perm_b32 v49, v20, v16, s21
v_perm_b32 v50, v28, v24, s21
v_perm_b32 v51, v36, v32, s21
v_add_u32 v5, 3072, v4
buffer_store_dwordx4 v[48:51], v5, s[12:15], 0 offen
s_nop 1
v_perm_b32 v48, v13, v9, s20
v_perm_b32 v49, v21, v17, s20
v_perm_b32 v50, v29, v25, s20
v_perm_b32 v51, v37, v33, s20
v_add_u32 v5, 6144, v4
buffer_store_dwordx4 v[48:51], v5, s[12:15], 0 offen
s_nop 1
v_perm_b32 v48, v13, v9, s21
v_perm_b32 v49, v21, v17, s21
v_perm_b32 v50, v29, v25, s21
v_perm_b32 v51, v37, v33, s21
v_add_u32 v5, 9216, v4
buffer_store_dwordx4 v[48:51], v5, s[12:15], 0 offen
s_nop 1
v_perm_b32 v48, v14, v10, s20
v_perm_b32 v49, v22, v18, s20
v_perm_b32 v50, v30, v26, s20
v_perm_b32 v51, v38, v34, s20
v_add_u32 v5, 12288, v4
buffer_store_dwordx4 v[48:51], v5, s[12:15], 0 offen
s_nop 1
v_perm_b32 v48, v14, v10, s21
v_perm_b32 v49, v22, v18, s21
v_perm_b32 v50, v30, v26, s21
v_perm_b32 v51, v38, v34, s21
v_add_u32 v5, 15360, v4
buffer_store_dwordx4 v[48:51], v5, s[12:15], 0 offen
s_nop 1
v_perm_b32 v48, v15, v11, s20
v_perm_b32 v49, v23, v19, s20
v_perm_b32 v50, v31, v27, s20
v_perm_b32 v51, v39, v35, s20
v_add_u32 v5, 18432, v4
buffer_store_dwordx4 v[48:51], v5, s[12:15], 0 offen
s_nop 1
v_perm_b32 v48, v15, v11, s21
v_perm_b32 v49, v23, v19, s21
v_perm_b32 v50, v31, v27, s21
v_perm_b32 v51, v39, v35, s21
v_add_u32 v5, 21504, v4
buffer_store_dwordx4 v[48:51], v5, s[12:15], 0 offen
s_nop 1
t2_kernel_e:
s_endpgm
.p2align 8
g1_kernel:
s_cmp_ge_u32 s2, 2304
s_cbranch_scc1 g1_kernel_e
s_load_dwordx2 s[90:91], s[0:1], 112
s_waitcnt lgkmcnt(0)
s_add_u32 s8, s90, 0
s_addc_u32 s9, s91, 0
s_mov_b32 s10, 2621440
s_mov_b32 s11, 0x00020000
s_load_dwordx2 s[90:91], s[0:1], 112
s_waitcnt lgkmcnt(0)
s_add_u32 s12, s90, 2621440
s_addc_u32 s13, s91, 0
s_mov_b32 s14, 23592960
s_mov_b32 s15, 0x00020000
s_and_b32 s24, s2, 15
s_lshr_b32 s25, s2, 4
s_mul_i32 s26, s24, 163840
s_mul_i32 s27, s25, 163840
v_add_u32 v2, 0, v0
v_lshrrev_b32 v3, 3, v2
v_and_b32 v4, 7, v2
v_mul_u32_u24 v5, 1280, v3
v_lshl_add_u32 v5, v4, 4, v5
v_add_u32 v128, s26, v5
v_add_u32 v132, s27, v5
v_mul_u32_u24 v5, 144, v3
v_lshl_add_u32 v136, v4, 4, v5
v_add_u32 v2, 256, v0
v_lshrrev_b32 v3, 3, v2
v_and_b32 v4, 7, v2
v_mul_u32_u24 v5, 1280, v3
v_lshl_add_u32 v5, v4, 4, v5
v_add_u32 v129, s26, v5
v_add_u32 v133, s27, v5
v_mul_u32_u24 v5, 144, v3
v_lshl_add_u32 v137, v4, 4, v5
v_add_u32 v2, 512, v0
v_lshrrev_b32 v3, 3, v2
v_and_b32 v4, 7, v2
v_mul_u32_u24 v5, 1280, v3
v_lshl_add_u32 v5, v4, 4, v5
v_add_u32 v130, s26, v5
v_add_u32 v134, s27, v5
v_mul_u32_u24 v5, 144, v3
v_lshl_add_u32 v138, v4, 4, v5
v_add_u32 v2, 768, v0
v_lshrrev_b32 v3, 3, v2
v_and_b32 v4, 7, v2
v_mul_u32_u24 v5, 1280, v3
v_lshl_add_u32 v5, v4, 4, v5
v_add_u32 v131, s26, v5
v_add_u32 v135, s27, v5
v_mul_u32_u24 v5, 144, v3
v_lshl_add_u32 v139, v4, 4, v5
v_lshrrev_b32 v2, 6, v0
v_and_b32 v3, 63, v0
v_lshrrev_b32 v4, 1, v2
v_and_b32 v5, 1, v2
v_and_b32 v6, 31, v3
v_lshrrev_b32 v7, 5, v3
v_mul_u32_u24 v140, 64, v4
v_add_u32 v140, v140, v6
v_mul_u32_u24 v140, 144, v140
v_lshl_add_u32 v140, v7, 4, v140
v_mul_u32_u24 v141, 64, v5
v_add_u32 v141, v141, v6
v_mul_u32_u24 v141, 144, v141
v_lshl_add_u32 v141, v7, 4, v141
v_add_u32 v141, 18432, v141
v_mov_b32 v64, 0
v_mov_b32 v65, 0
v_mov_b32 v66, 0
v_mov_b32 v67, 0
v_mov_b32 v68, 0
v_mov_b32 v69, 0
v_mov_b32 v70, 0
v_mov_b32 v71, 0
v_mov_b32 v72, 0
v_mov_b32 v73, 0
v_mov_b32 v74, 0
v_mov_b32 v75, 0
v_mov_b32 v76, 0
v_mov_b32 v77, 0
v_mov_b32 v78, 0
v_mov_b32 v79, 0
v_mov_b32 v80, 0
v_mov_b32 v81, 0
v_mov_b32 v82, 0
v_mov_b32 v83, 0
v_mov_b32 v84, 0
v_mov_b32 v85, 0
v_mov_b32 v86, 0
v_mov_b32 v87, 0
v_mov_b32 v88, 0
v_mov_b32 v89, 0
v_mov_b32 v90, 0
v_mov_b32 v91, 0
v_mov_b32 v92, 0
v_mov_b32 v93, 0
v_mov_b32 v94, 0
v_mov_b32 v95, 0
v_mov_b32 v96, 0
v_mov_b32 v97, 0
v_mov_b32 v98, 0
v_mov_b32 v99, 0
v_mov_b32 v100, 0
v_mov_b32 v101, 0
v_mov_b32 v102, 0
v_mov_b32 v103, 0
v_mov_b32 v104, 0
v_mov_b32 v105, 0
v_mov_b32 v106, 0
v_mov_b32 v107, 0
v_mov_b32 v108, 0
v_mov_b32 v109, 0
v_mov_b32 v110, 0
v_mov_b32 v111, 0
v_mov_b32 v112, 0
v_mov_b32 v113, 0
v_mov_b32 v114, 0
v_mov_b32 v115, 0
v_mov_b32 v116, 0
v_mov_b32 v117, 0
v_mov_b32 v118, 0
v_mov_b32 v119, 0
v_mov_b32 v120, 0
v_mov_b32 v121, 0
v_mov_b32 v122, 0
v_mov_b32 v123, 0
v_mov_b32 v124, 0
v_mov_b32 v125, 0
v_mov_b32 v126, 0
v_mov_b32 v127, 0
s_mov_b32 s28, 0
buffer_load_dwordx4 v[32:35], v128, s[8:11], s28 offen
buffer_load_dwordx4 v[48:51], v132, s[12:15], s28 offen
buffer_load_dwordx4 v[36:39], v129, s[8:11], s28 offen
buffer_load_dwordx4 v[52:55], v133, s[12:15], s28 offen
buffer_load_dwordx4 v[40:43], v130, s[8:11], s28 offen
buffer_load_dwordx4 v[56:59], v134, s[12:15], s28 offen
buffer_load_dwordx4 v[44:47], v131, s[8:11], s28 offen
buffer_load_dwordx4 v[60:63], v135, s[12:15], s28 offen
g1_kernel_l:
s_waitcnt vmcnt(0)
ds_write_b128 v136, v[32:35]
ds_write_b128 v136, v[48:51] offset:18432
ds_write_b128 v137, v[36:39]
ds_write_b128 v137, v[52:55] offset:18432
ds_write_b128 v138, v[40:43]
ds_write_b128 v138, v[56:59] offset:18432
ds_write_b128 v139, v[44:47]
ds_write_b128 v139, v[60:63] offset:18432
s_waitcnt lgkmcnt(0)
s_barrier
s_add_u32 s28, s28, 128
buffer_load_dwordx4 v[32:35], v128, s[8:11], s28 offen
buffer_load_dwordx4 v[48:51], v132, s[12:15], s28 offen
buffer_load_dwordx4 v[36:39], v129, s[8:11], s28 offen
buffer_load_dwordx4 v[52:55], v133, s[12:15], s28 offen
buffer_load_dwordx4 v[40:43], v130, s[8:11], s28 offen
buffer_load_dwordx4 v[56:59], v134, s[12:15], s28 offen
buffer_load_dwordx4 v[44:47], v131, s[8:11], s28 offen
buffer_load_dwordx4 v[60:63], v135, s[12:15], s28 offen
ds_read_b128 v[8:11], v140 offset:0
ds_read_b128 v[16:19], v141 offset:0
ds_read_b128 v[12:15], v140 offset:4608
ds_read_b128 v[20:23], v141 offset:4608
s_waitcnt lgkmcnt(0)
v_mfma_f32_32x32x16_bf16 v[64:79], v[8:11], v[16:19], v[64:79]
v_mfma_f32_32x32x16_bf16 v[80:95], v[8:11], v[20:23], v[80:95]
v_mfma_f32_32x32x16_bf16 v[96:111], v[12:15], v[16:19], v[96:111]
v_mfma_f32_32x32x16_bf16 v[112:127], v[12:15], v[20:23], v[112:127]
ds_read_b128 v[8:11], v140 offset:32
ds_read_b128 v[16:19], v141 offset:32
ds_read_b128 v[12:15], v140 offset:4640
ds_read_b128 v[20:23], v141 offset:4640
s_waitcnt lgkmcnt(0)
v_mfma_f32_32x32x16_bf16 v[64:79], v[8:11], v[16:19], v[64:79]
v_mfma_f32_32x32x16_bf16 v[80:95], v[8:11], v[20:23], v[80:95]
v_mfma_f32_32x32x16_bf16 v[96:111], v[12:15], v[16:19], v[96:111]
v_mfma_f32_32x32x16_bf16 v[112:127], v[12:15], v[20:23], v[112:127]
ds_read_b128 v[8:11], v140 offset:64
ds_read_b128 v[16:19], v141 offset:64
ds_read_b128 v[12:15], v140 offset:4672
ds_read_b128 v[20:23], v141 offset:4672
s_waitcnt lgkmcnt(0)
v_mfma_f32_32x32x16_bf16 v[64:79], v[8:11], v[16:19], v[64:79]
v_mfma_f32_32x32x16_bf16 v[80:95], v[8:11], v[20:23], v[80:95]
v_mfma_f32_32x32x16_bf16 v[96:111], v[12:15], v[16:19], v[96:111]
v_mfma_f32_32x32x16_bf16 v[112:127], v[12:15], v[20:23], v[112:127]
ds_read_b128 v[8:11], v140 offset:96
ds_read_b128 v[16:19], v141 offset:96
ds_read_b128 v[12:15], v140 offset:4704
ds_read_b128 v[20:23], v141 offset:4704
s_waitcnt lgkmcnt(0)
v_mfma_f32_32x32x16_bf16 v[64:79], v[8:11], v[16:19], v[64:79]
v_mfma_f32_32x32x16_bf16 v[80:95], v[8:11], v[20:23], v[80:95]
v_mfma_f32_32x32x16_bf16 v[96:111], v[12:15], v[16:19], v[96:111]
v_mfma_f32_32x32x16_bf16 v[112:127], v[12:15], v[20:23], v[112:127]
s_barrier
s_cmp_lt_u32 s28, 1280
s_cbranch_scc1 g1_kernel_l
s_nop 15
s_waitcnt vmcnt(0)
s_mul_i32 s26, s24, 128
s_mul_i32 s27, s25, 128
v_mul_u32_u24 v8, 64, v4
v_lshl_add_u32 v8, v7, 2, v8
v_add_u32 v8, s26, v8
v_mul_u32_u24 v9, 64, v5
v_add_u32 v9, v9, v6
v_add_u32 v9, s27, v9
s_load_dwordx2 s[90:91], s[0:1], 112
s_waitcnt lgkmcnt(0)
s_add_u32 s16, s90, 38010880
s_addc_u32 s17, s91, 0
s_mov_b32 s18, 50331648
s_mov_b32 s19, 0x00020000
s_load_dwordx2 s[90:91], s[0:1], 112
s_waitcnt lgkmcnt(0)
s_add_u32 s20, s90, 88342528
s_addc_u32 s21, s91, 0
s_mov_b32 s22, 25165824
s_mov_b32 s23, 0x00020000
s_cmp_ge_u32 s27, 12288
s_cbranch_scc1 g1_kernel_v
s_cmp_ge_u32 s27, 6144
s_cselect_b32 s29, 25153536, 0
v_add_u32 v10, 0, v8
v_mul_u32_u24 v10, 12288, v10
v_add_u32 v11, 0, v9
v_lshl_add_u32 v10, v11, 1, v10
v_cvt_pk_bf16_f32 v12, v64, v64
buffer_store_short v12, v10, s[16:19], s29 offen
v_add_u32 v10, 1, v8
v_mul_u32_u24 v10, 12288, v10
v_add_u32 v11, 0, v9
v_lshl_add_u32 v10, v11, 1, v10
v_cvt_pk_bf16_f32 v12, v65, v65
buffer_store_short v12, v10, s[16:19], s29 offen
v_add_u32 v10, 2, v8
v_mul_u32_u24 v10, 12288, v10
v_add_u32 v11, 0, v9
v_lshl_add_u32 v10, v11, 1, v10
v_cvt_pk_bf16_f32 v12, v66, v66
buffer_store_short v12, v10, s[16:19], s29 offen
v_add_u32 v10, 3, v8
v_mul_u32_u24 v10, 12288, v10
v_add_u32 v11, 0, v9
v_lshl_add_u32 v10, v11, 1, v10
v_cvt_pk_bf16_f32 v12, v67, v67
buffer_store_short v12, v10, s[16:19], s29 offen
v_add_u32 v10, 8, v8
v_mul_u32_u24 v10, 12288, v10
v_add_u32 v11, 0, v9
v_lshl_add_u32 v10, v11, 1, v10
v_cvt_pk_bf16_f32 v12, v68, v68
buffer_store_short v12, v10, s[16:19], s29 offen
v_add_u32 v10, 9, v8
v_mul_u32_u24 v10, 12288, v10
v_add_u32 v11, 0, v9
v_lshl_add_u32 v10, v11, 1, v10
v_cvt_pk_bf16_f32 v12, v69, v69
buffer_store_short v12, v10, s[16:19], s29 offen
v_add_u32 v10, 10, v8
v_mul_u32_u24 v10, 12288, v10
v_add_u32 v11, 0, v9
v_lshl_add_u32 v10, v11, 1, v10
v_cvt_pk_bf16_f32 v12, v70, v70
buffer_store_short v12, v10, s[16:19], s29 offen
v_add_u32 v10, 11, v8
v_mul_u32_u24 v10, 12288, v10
v_add_u32 v11, 0, v9
v_lshl_add_u32 v10, v11, 1, v10
v_cvt_pk_bf16_f32 v12, v71, v71
buffer_store_short v12, v10, s[16:19], s29 offen
v_add_u32 v10, 16, v8
v_mul_u32_u24 v10, 12288, v10
v_add_u32 v11, 0, v9
v_lshl_add_u32 v10, v11, 1, v10
v_cvt_pk_bf16_f32 v12, v72, v72
buffer_store_short v12, v10, s[16:19], s29 offen
v_add_u32 v10, 17, v8
v_mul_u32_u24 v10, 12288, v10
v_add_u32 v11, 0, v9
v_lshl_add_u32 v10, v11, 1, v10
v_cvt_pk_bf16_f32 v12, v73, v73
buffer_store_short v12, v10, s[16:19], s29 offen
v_add_u32 v10, 18, v8
v_mul_u32_u24 v10, 12288, v10
v_add_u32 v11, 0, v9
v_lshl_add_u32 v10, v11, 1, v10
v_cvt_pk_bf16_f32 v12, v74, v74
buffer_store_short v12, v10, s[16:19], s29 offen
v_add_u32 v10, 19, v8
v_mul_u32_u24 v10, 12288, v10
v_add_u32 v11, 0, v9
v_lshl_add_u32 v10, v11, 1, v10
v_cvt_pk_bf16_f32 v12, v75, v75
buffer_store_short v12, v10, s[16:19], s29 offen
v_add_u32 v10, 24, v8
v_mul_u32_u24 v10, 12288, v10
v_add_u32 v11, 0, v9
v_lshl_add_u32 v10, v11, 1, v10
v_cvt_pk_bf16_f32 v12, v76, v76
buffer_store_short v12, v10, s[16:19], s29 offen
v_add_u32 v10, 25, v8
v_mul_u32_u24 v10, 12288, v10
v_add_u32 v11, 0, v9
v_lshl_add_u32 v10, v11, 1, v10
v_cvt_pk_bf16_f32 v12, v77, v77
buffer_store_short v12, v10, s[16:19], s29 offen
v_add_u32 v10, 26, v8
v_mul_u32_u24 v10, 12288, v10
v_add_u32 v11, 0, v9
v_lshl_add_u32 v10, v11, 1, v10
v_cvt_pk_bf16_f32 v12, v78, v78
buffer_store_short v12, v10, s[16:19], s29 offen
v_add_u32 v10, 27, v8
v_mul_u32_u24 v10, 12288, v10
v_add_u32 v11, 0, v9
v_lshl_add_u32 v10, v11, 1, v10
v_cvt_pk_bf16_f32 v12, v79, v79
buffer_store_short v12, v10, s[16:19], s29 offen
v_add_u32 v10, 0, v8
v_mul_u32_u24 v10, 12288, v10
v_add_u32 v11, 32, v9
v_lshl_add_u32 v10, v11, 1, v10
v_cvt_pk_bf16_f32 v12, v80, v80
buffer_store_short v12, v10, s[16:19], s29 offen
v_add_u32 v10, 1, v8
v_mul_u32_u24 v10, 12288, v10
v_add_u32 v11, 32, v9
v_lshl_add_u32 v10, v11, 1, v10
v_cvt_pk_bf16_f32 v12, v81, v81
buffer_store_short v12, v10, s[16:19], s29 offen
v_add_u32 v10, 2, v8
v_mul_u32_u24 v10, 12288, v10
v_add_u32 v11, 32, v9
v_lshl_add_u32 v10, v11, 1, v10
v_cvt_pk_bf16_f32 v12, v82, v82
buffer_store_short v12, v10, s[16:19], s29 offen
v_add_u32 v10, 3, v8
v_mul_u32_u24 v10, 12288, v10
v_add_u32 v11, 32, v9
v_lshl_add_u32 v10, v11, 1, v10
v_cvt_pk_bf16_f32 v12, v83, v83
buffer_store_short v12, v10, s[16:19], s29 offen
v_add_u32 v10, 8, v8
v_mul_u32_u24 v10, 12288, v10
v_add_u32 v11, 32, v9
v_lshl_add_u32 v10, v11, 1, v10
v_cvt_pk_bf16_f32 v12, v84, v84
buffer_store_short v12, v10, s[16:19], s29 offen
v_add_u32 v10, 9, v8
v_mul_u32_u24 v10, 12288, v10
v_add_u32 v11, 32, v9
v_lshl_add_u32 v10, v11, 1, v10
v_cvt_pk_bf16_f32 v12, v85, v85
buffer_store_short v12, v10, s[16:19], s29 offen
v_add_u32 v10, 10, v8
v_mul_u32_u24 v10, 12288, v10
v_add_u32 v11, 32, v9
v_lshl_add_u32 v10, v11, 1, v10
v_cvt_pk_bf16_f32 v12, v86, v86
buffer_store_short v12, v10, s[16:19], s29 offen
v_add_u32 v10, 11, v8
v_mul_u32_u24 v10, 12288, v10
v_add_u32 v11, 32, v9
v_lshl_add_u32 v10, v11, 1, v10
v_cvt_pk_bf16_f32 v12, v87, v87
buffer_store_short v12, v10, s[16:19], s29 offen
v_add_u32 v10, 16, v8
v_mul_u32_u24 v10, 12288, v10
v_add_u32 v11, 32, v9
v_lshl_add_u32 v10, v11, 1, v10
v_cvt_pk_bf16_f32 v12, v88, v88
buffer_store_short v12, v10, s[16:19], s29 offen
v_add_u32 v10, 17, v8
v_mul_u32_u24 v10, 12288, v10
v_add_u32 v11, 32, v9
v_lshl_add_u32 v10, v11, 1, v10
v_cvt_pk_bf16_f32 v12, v89, v89
buffer_store_short v12, v10, s[16:19], s29 offen
v_add_u32 v10, 18, v8
v_mul_u32_u24 v10, 12288, v10
v_add_u32 v11, 32, v9
v_lshl_add_u32 v10, v11, 1, v10
v_cvt_pk_bf16_f32 v12, v90, v90
buffer_store_short v12, v10, s[16:19], s29 offen
v_add_u32 v10, 19, v8
v_mul_u32_u24 v10, 12288, v10
v_add_u32 v11, 32, v9
v_lshl_add_u32 v10, v11, 1, v10
v_cvt_pk_bf16_f32 v12, v91, v91
buffer_store_short v12, v10, s[16:19], s29 offen
v_add_u32 v10, 24, v8
v_mul_u32_u24 v10, 12288, v10
v_add_u32 v11, 32, v9
v_lshl_add_u32 v10, v11, 1, v10
v_cvt_pk_bf16_f32 v12, v92, v92
buffer_store_short v12, v10, s[16:19], s29 offen
v_add_u32 v10, 25, v8
v_mul_u32_u24 v10, 12288, v10
v_add_u32 v11, 32, v9
v_lshl_add_u32 v10, v11, 1, v10
v_cvt_pk_bf16_f32 v12, v93, v93
buffer_store_short v12, v10, s[16:19], s29 offen
v_add_u32 v10, 26, v8
v_mul_u32_u24 v10, 12288, v10
v_add_u32 v11, 32, v9
v_lshl_add_u32 v10, v11, 1, v10
v_cvt_pk_bf16_f32 v12, v94, v94
buffer_store_short v12, v10, s[16:19], s29 offen
v_add_u32 v10, 27, v8
v_mul_u32_u24 v10, 12288, v10
v_add_u32 v11, 32, v9
v_lshl_add_u32 v10, v11, 1, v10
v_cvt_pk_bf16_f32 v12, v95, v95
buffer_store_short v12, v10, s[16:19], s29 offen
v_add_u32 v10, 32, v8
v_mul_u32_u24 v10, 12288, v10
v_add_u32 v11, 0, v9
v_lshl_add_u32 v10, v11, 1, v10
v_cvt_pk_bf16_f32 v12, v96, v96
buffer_store_short v12, v10, s[16:19], s29 offen
v_add_u32 v10, 33, v8
v_mul_u32_u24 v10, 12288, v10
v_add_u32 v11, 0, v9
v_lshl_add_u32 v10, v11, 1, v10
v_cvt_pk_bf16_f32 v12, v97, v97
buffer_store_short v12, v10, s[16:19], s29 offen
v_add_u32 v10, 34, v8
v_mul_u32_u24 v10, 12288, v10
v_add_u32 v11, 0, v9
v_lshl_add_u32 v10, v11, 1, v10
v_cvt_pk_bf16_f32 v12, v98, v98
buffer_store_short v12, v10, s[16:19], s29 offen
v_add_u32 v10, 35, v8
v_mul_u32_u24 v10, 12288, v10
v_add_u32 v11, 0, v9
v_lshl_add_u32 v10, v11, 1, v10
v_cvt_pk_bf16_f32 v12, v99, v99
buffer_store_short v12, v10, s[16:19], s29 offen
v_add_u32 v10, 40, v8
v_mul_u32_u24 v10, 12288, v10
v_add_u32 v11, 0, v9
v_lshl_add_u32 v10, v11, 1, v10
v_cvt_pk_bf16_f32 v12, v100, v100
buffer_store_short v12, v10, s[16:19], s29 offen
v_add_u32 v10, 41, v8
v_mul_u32_u24 v10, 12288, v10
v_add_u32 v11, 0, v9
v_lshl_add_u32 v10, v11, 1, v10
v_cvt_pk_bf16_f32 v12, v101, v101
buffer_store_short v12, v10, s[16:19], s29 offen
v_add_u32 v10, 42, v8
v_mul_u32_u24 v10, 12288, v10
v_add_u32 v11, 0, v9
v_lshl_add_u32 v10, v11, 1, v10
v_cvt_pk_bf16_f32 v12, v102, v102
buffer_store_short v12, v10, s[16:19], s29 offen
v_add_u32 v10, 43, v8
v_mul_u32_u24 v10, 12288, v10
v_add_u32 v11, 0, v9
v_lshl_add_u32 v10, v11, 1, v10
v_cvt_pk_bf16_f32 v12, v103, v103
buffer_store_short v12, v10, s[16:19], s29 offen
v_add_u32 v10, 48, v8
v_mul_u32_u24 v10, 12288, v10
v_add_u32 v11, 0, v9
v_lshl_add_u32 v10, v11, 1, v10
v_cvt_pk_bf16_f32 v12, v104, v104
buffer_store_short v12, v10, s[16:19], s29 offen
v_add_u32 v10, 49, v8
v_mul_u32_u24 v10, 12288, v10
v_add_u32 v11, 0, v9
v_lshl_add_u32 v10, v11, 1, v10
v_cvt_pk_bf16_f32 v12, v105, v105
buffer_store_short v12, v10, s[16:19], s29 offen
v_add_u32 v10, 50, v8
v_mul_u32_u24 v10, 12288, v10
v_add_u32 v11, 0, v9
v_lshl_add_u32 v10, v11, 1, v10
v_cvt_pk_bf16_f32 v12, v106, v106
buffer_store_short v12, v10, s[16:19], s29 offen
v_add_u32 v10, 51, v8
v_mul_u32_u24 v10, 12288, v10
v_add_u32 v11, 0, v9
v_lshl_add_u32 v10, v11, 1, v10
v_cvt_pk_bf16_f32 v12, v107, v107
buffer_store_short v12, v10, s[16:19], s29 offen
v_add_u32 v10, 56, v8
v_mul_u32_u24 v10, 12288, v10
v_add_u32 v11, 0, v9
v_lshl_add_u32 v10, v11, 1, v10
v_cvt_pk_bf16_f32 v12, v108, v108
buffer_store_short v12, v10, s[16:19], s29 offen
v_add_u32 v10, 57, v8
v_mul_u32_u24 v10, 12288, v10
v_add_u32 v11, 0, v9
v_lshl_add_u32 v10, v11, 1, v10
v_cvt_pk_bf16_f32 v12, v109, v109
buffer_store_short v12, v10, s[16:19], s29 offen
v_add_u32 v10, 58, v8
v_mul_u32_u24 v10, 12288, v10
v_add_u32 v11, 0, v9
v_lshl_add_u32 v10, v11, 1, v10
v_cvt_pk_bf16_f32 v12, v110, v110
buffer_store_short v12, v10, s[16:19], s29 offen
v_add_u32 v10, 59, v8
v_mul_u32_u24 v10, 12288, v10
v_add_u32 v11, 0, v9
v_lshl_add_u32 v10, v11, 1, v10
v_cvt_pk_bf16_f32 v12, v111, v111
buffer_store_short v12, v10, s[16:19], s29 offen
v_add_u32 v10, 32, v8
v_mul_u32_u24 v10, 12288, v10
v_add_u32 v11, 32, v9
v_lshl_add_u32 v10, v11, 1, v10
v_cvt_pk_bf16_f32 v12, v112, v112
buffer_store_short v12, v10, s[16:19], s29 offen
v_add_u32 v10, 33, v8
v_mul_u32_u24 v10, 12288, v10
v_add_u32 v11, 32, v9
v_lshl_add_u32 v10, v11, 1, v10
v_cvt_pk_bf16_f32 v12, v113, v113
buffer_store_short v12, v10, s[16:19], s29 offen
v_add_u32 v10, 34, v8
v_mul_u32_u24 v10, 12288, v10
v_add_u32 v11, 32, v9
v_lshl_add_u32 v10, v11, 1, v10
v_cvt_pk_bf16_f32 v12, v114, v114
buffer_store_short v12, v10, s[16:19], s29 offen
v_add_u32 v10, 35, v8
v_mul_u32_u24 v10, 12288, v10
v_add_u32 v11, 32, v9
v_lshl_add_u32 v10, v11, 1, v10
v_cvt_pk_bf16_f32 v12, v115, v115
buffer_store_short v12, v10, s[16:19], s29 offen
v_add_u32 v10, 40, v8
v_mul_u32_u24 v10, 12288, v10
v_add_u32 v11, 32, v9
v_lshl_add_u32 v10, v11, 1, v10
v_cvt_pk_bf16_f32 v12, v116, v116
buffer_store_short v12, v10, s[16:19], s29 offen
v_add_u32 v10, 41, v8
v_mul_u32_u24 v10, 12288, v10
v_add_u32 v11, 32, v9
v_lshl_add_u32 v10, v11, 1, v10
v_cvt_pk_bf16_f32 v12, v117, v117
buffer_store_short v12, v10, s[16:19], s29 offen
v_add_u32 v10, 42, v8
v_mul_u32_u24 v10, 12288, v10
v_add_u32 v11, 32, v9
v_lshl_add_u32 v10, v11, 1, v10
v_cvt_pk_bf16_f32 v12, v118, v118
buffer_store_short v12, v10, s[16:19], s29 offen
v_add_u32 v10, 43, v8
v_mul_u32_u24 v10, 12288, v10
v_add_u32 v11, 32, v9
v_lshl_add_u32 v10, v11, 1, v10
v_cvt_pk_bf16_f32 v12, v119, v119
buffer_store_short v12, v10, s[16:19], s29 offen
v_add_u32 v10, 48, v8
v_mul_u32_u24 v10, 12288, v10
v_add_u32 v11, 32, v9
v_lshl_add_u32 v10, v11, 1, v10
v_cvt_pk_bf16_f32 v12, v120, v120
buffer_store_short v12, v10, s[16:19], s29 offen
v_add_u32 v10, 49, v8
v_mul_u32_u24 v10, 12288, v10
v_add_u32 v11, 32, v9
v_lshl_add_u32 v10, v11, 1, v10
v_cvt_pk_bf16_f32 v12, v121, v121
buffer_store_short v12, v10, s[16:19], s29 offen
v_add_u32 v10, 50, v8
v_mul_u32_u24 v10, 12288, v10
v_add_u32 v11, 32, v9
v_lshl_add_u32 v10, v11, 1, v10
v_cvt_pk_bf16_f32 v12, v122, v122
buffer_store_short v12, v10, s[16:19], s29 offen
v_add_u32 v10, 51, v8
v_mul_u32_u24 v10, 12288, v10
v_add_u32 v11, 32, v9
v_lshl_add_u32 v10, v11, 1, v10
v_cvt_pk_bf16_f32 v12, v123, v123
buffer_store_short v12, v10, s[16:19], s29 offen
v_add_u32 v10, 56, v8
v_mul_u32_u24 v10, 12288, v10
v_add_u32 v11, 32, v9
v_lshl_add_u32 v10, v11, 1, v10
v_cvt_pk_bf16_f32 v12, v124, v124
buffer_store_short v12, v10, s[16:19], s29 offen
v_add_u32 v10, 57, v8
v_mul_u32_u24 v10, 12288, v10
v_add_u32 v11, 32, v9
v_lshl_add_u32 v10, v11, 1, v10
v_cvt_pk_bf16_f32 v12, v125, v125
buffer_store_short v12, v10, s[16:19], s29 offen
v_add_u32 v10, 58, v8
v_mul_u32_u24 v10, 12288, v10
v_add_u32 v11, 32, v9
v_lshl_add_u32 v10, v11, 1, v10
v_cvt_pk_bf16_f32 v12, v126, v126
buffer_store_short v12, v10, s[16:19], s29 offen
v_add_u32 v10, 59, v8
v_mul_u32_u24 v10, 12288, v10
v_add_u32 v11, 32, v9
v_lshl_add_u32 v10, v11, 1, v10
v_cvt_pk_bf16_f32 v12, v127, v127
buffer_store_short v12, v10, s[16:19], s29 offen
s_branch g1_kernel_e
g1_kernel_v:
v_add_u32 v11, -12288, v9
v_lshlrev_b32 v10, 12, v11
v_add_u32 v11, 0, v8
v_lshl_add_u32 v10, v11, 1, v10
v_cvt_pk_bf16_f32 v12, v64, v65
v_cvt_pk_bf16_f32 v13, v66, v67
buffer_store_dwordx2 v[12:13], v10, s[20:23], 0 offen
v_add_u32 v11, -12288, v9
v_lshlrev_b32 v10, 12, v11
v_add_u32 v11, 8, v8
v_lshl_add_u32 v10, v11, 1, v10
v_cvt_pk_bf16_f32 v12, v68, v69
v_cvt_pk_bf16_f32 v13, v70, v71
buffer_store_dwordx2 v[12:13], v10, s[20:23], 0 offen
v_add_u32 v11, -12288, v9
v_lshlrev_b32 v10, 12, v11
v_add_u32 v11, 16, v8
v_lshl_add_u32 v10, v11, 1, v10
v_cvt_pk_bf16_f32 v12, v72, v73
v_cvt_pk_bf16_f32 v13, v74, v75
buffer_store_dwordx2 v[12:13], v10, s[20:23], 0 offen
v_add_u32 v11, -12288, v9
v_lshlrev_b32 v10, 12, v11
v_add_u32 v11, 24, v8
v_lshl_add_u32 v10, v11, 1, v10
v_cvt_pk_bf16_f32 v12, v76, v77
v_cvt_pk_bf16_f32 v13, v78, v79
buffer_store_dwordx2 v[12:13], v10, s[20:23], 0 offen
v_add_u32 v11, -12256, v9
v_lshlrev_b32 v10, 12, v11
v_add_u32 v11, 0, v8
v_lshl_add_u32 v10, v11, 1, v10
v_cvt_pk_bf16_f32 v12, v80, v81
v_cvt_pk_bf16_f32 v13, v82, v83
buffer_store_dwordx2 v[12:13], v10, s[20:23], 0 offen
v_add_u32 v11, -12256, v9
v_lshlrev_b32 v10, 12, v11
v_add_u32 v11, 8, v8
v_lshl_add_u32 v10, v11, 1, v10
v_cvt_pk_bf16_f32 v12, v84, v85
v_cvt_pk_bf16_f32 v13, v86, v87
buffer_store_dwordx2 v[12:13], v10, s[20:23], 0 offen
v_add_u32 v11, -12256, v9
v_lshlrev_b32 v10, 12, v11
v_add_u32 v11, 16, v8
v_lshl_add_u32 v10, v11, 1, v10
v_cvt_pk_bf16_f32 v12, v88, v89
v_cvt_pk_bf16_f32 v13, v90, v91
buffer_store_dwordx2 v[12:13], v10, s[20:23], 0 offen
v_add_u32 v11, -12256, v9
v_lshlrev_b32 v10, 12, v11
v_add_u32 v11, 24, v8
v_lshl_add_u32 v10, v11, 1, v10
v_cvt_pk_bf16_f32 v12, v92, v93
v_cvt_pk_bf16_f32 v13, v94, v95
buffer_store_dwordx2 v[12:13], v10, s[20:23], 0 offen
v_add_u32 v11, -12288, v9
v_lshlrev_b32 v10, 12, v11
v_add_u32 v11, 32, v8
v_lshl_add_u32 v10, v11, 1, v10
v_cvt_pk_bf16_f32 v12, v96, v97
v_cvt_pk_bf16_f32 v13, v98, v99
buffer_store_dwordx2 v[12:13], v10, s[20:23], 0 offen
v_add_u32 v11, -12288, v9
v_lshlrev_b32 v10, 12, v11
v_add_u32 v11, 40, v8
v_lshl_add_u32 v10, v11, 1, v10
v_cvt_pk_bf16_f32 v12, v100, v101
v_cvt_pk_bf16_f32 v13, v102, v103
buffer_store_dwordx2 v[12:13], v10, s[20:23], 0 offen
v_add_u32 v11, -12288, v9
v_lshlrev_b32 v10, 12, v11
v_add_u32 v11, 48, v8
v_lshl_add_u32 v10, v11, 1, v10
v_cvt_pk_bf16_f32 v12, v104, v105
v_cvt_pk_bf16_f32 v13, v106, v107
buffer_store_dwordx2 v[12:13], v10, s[20:23], 0 offen
v_add_u32 v11, -12288, v9
v_lshlrev_b32 v10, 12, v11
v_add_u32 v11, 56, v8
v_lshl_add_u32 v10, v11, 1, v10
v_cvt_pk_bf16_f32 v12, v108, v109
v_cvt_pk_bf16_f32 v13, v110, v111
buffer_store_dwordx2 v[12:13], v10, s[20:23], 0 offen
v_add_u32 v11, -12256, v9
v_lshlrev_b32 v10, 12, v11
v_add_u32 v11, 32, v8
v_lshl_add_u32 v10, v11, 1, v10
v_cvt_pk_bf16_f32 v12, v112, v113
v_cvt_pk_bf16_f32 v13, v114, v115
buffer_store_dwordx2 v[12:13], v10, s[20:23], 0 offen
v_add_u32 v11, -12256, v9
v_lshlrev_b32 v10, 12, v11
v_add_u32 v11, 40, v8
v_lshl_add_u32 v10, v11, 1, v10
v_cvt_pk_bf16_f32 v12, v116, v117
v_cvt_pk_bf16_f32 v13, v118, v119
buffer_store_dwordx2 v[12:13], v10, s[20:23], 0 offen
v_add_u32 v11, -12256, v9
v_lshlrev_b32 v10, 12, v11
v_add_u32 v11, 48, v8
v_lshl_add_u32 v10, v11, 1, v10
v_cvt_pk_bf16_f32 v12, v120, v121
v_cvt_pk_bf16_f32 v13, v122, v123
buffer_store_dwordx2 v[12:13], v10, s[20:23], 0 offen
v_add_u32 v11, -12256, v9
v_lshlrev_b32 v10, 12, v11
v_add_u32 v11, 56, v8
v_lshl_add_u32 v10, v11, 1, v10
v_cvt_pk_bf16_f32 v12, v124, v125
v_cvt_pk_bf16_f32 v13, v126, v127
buffer_store_dwordx2 v[12:13], v10, s[20:23], 0 offen
g1_kernel_e:
s_endpgm
.p2align 8
ch_kernel:
s_cmp_ge_u32 s2, 128
s_cbranch_scc1 ch_kernel_e
s_load_dwordx2 s[90:91], s[0:1], 112
s_waitcnt lgkmcnt(0)
s_add_u32 s8, s90, 0
s_addc_u32 s9, s91, 0
s_mov_b32 s10, 268435200
s_mov_b32 s11, 0x00020000
s_load_dwordx2 s[90:91], s[0:1], 8
s_waitcnt lgkmcnt(0)
s_add_u32 s12, s90, 0
s_addc_u32 s13, s91, 0
s_mov_b32 s14, 10240
s_mov_b32 s15, 0x00020000
v_lshrrev_b32 v1, 6, v0
v_and_b32 v2, 63, v0
v_and_b32 v6, 15, v2
v_lshrrev_b32 v7, 4, v2
v_lshlrev_b32 v3, 2, v2
s_lshr_b32 s41, s2, 2
s_and_b32 s42, s2, 3
s_mul_i32 s43, s41, 192
s_mul_i32 s44, s42, 48
s_add_u32 s43, s43, s44
v_add_u32 v10, 0, v6
v_add_u32 v10, s43, v10
v_mul_u32_u24 v10, 1280, v10
v_mul_u32_u24 v11, 320, v1
v_add_u32 v10, v10, v11
v_lshl_add_u32 v10, v7, 4, v10
v_add_u32 v10, 2621440, v10
buffer_load_dwordx4 v[20:23], v10, s[8:11], 0 offen offset:0
s_waitcnt vmcnt(0)
v_accvgpr_write_b32 a0, v20
v_accvgpr_write_b32 a1, v21
v_accvgpr_write_b32 a2, v22
v_accvgpr_write_b32 a3, v23
buffer_load_dwordx4 v[20:23], v10, s[8:11], 0 offen offset:64
s_waitcnt vmcnt(0)
v_accvgpr_write_b32 a4, v20
v_accvgpr_write_b32 a5, v21
v_accvgpr_write_b32 a6, v22
v_accvgpr_write_b32 a7, v23
buffer_load_dwordx4 v[20:23], v10, s[8:11], 0 offen offset:128
s_waitcnt vmcnt(0)
v_accvgpr_write_b32 a8, v20
v_accvgpr_write_b32 a9, v21
v_accvgpr_write_b32 a10, v22
v_accvgpr_write_b32 a11, v23
buffer_load_dwordx4 v[20:23], v10, s[8:11], 0 offen offset:192
s_waitcnt vmcnt(0)
v_accvgpr_write_b32 a12, v20
v_accvgpr_write_b32 a13, v21
v_accvgpr_write_b32 a14, v22
v_accvgpr_write_b32 a15, v23
buffer_load_dwordx4 v[20:23], v10, s[8:11], 0 offen offset:256
s_waitcnt vmcnt(0)
v_accvgpr_write_b32 a16, v20
v_accvgpr_write_b32 a17, v21
v_accvgpr_write_b32 a18, v22
v_accvgpr_write_b32 a19, v23
v_add_u32 v10, 16, v6
v_add_u32 v10, s43, v10
v_mul_u32_u24 v10, 1280, v10
v_mul_u32_u24 v11, 320, v1
v_add_u32 v10, v10, v11
v_lshl_add_u32 v10, v7, 4, v10
v_add_u32 v10, 2621440, v10
buffer_load_dwordx4 v[20:23], v10, s[8:11], 0 offen offset:0
s_waitcnt vmcnt(0)
v_accvgpr_write_b32 a20, v20
v_accvgpr_write_b32 a21, v21
v_accvgpr_write_b32 a22, v22
v_accvgpr_write_b32 a23, v23
buffer_load_dwordx4 v[20:23], v10, s[8:11], 0 offen offset:64
s_waitcnt vmcnt(0)
v_accvgpr_write_b32 a24, v20
v_accvgpr_write_b32 a25, v21
v_accvgpr_write_b32 a26, v22
v_accvgpr_write_b32 a27, v23
buffer_load_dwordx4 v[20:23], v10, s[8:11], 0 offen offset:128
s_waitcnt vmcnt(0)
v_accvgpr_write_b32 a28, v20
v_accvgpr_write_b32 a29, v21
v_accvgpr_write_b32 a30, v22
v_accvgpr_write_b32 a31, v23
buffer_load_dwordx4 v[20:23], v10, s[8:11], 0 offen offset:192
s_waitcnt vmcnt(0)
v_accvgpr_write_b32 a32, v20
v_accvgpr_write_b32 a33, v21
v_accvgpr_write_b32 a34, v22
v_accvgpr_write_b32 a35, v23
buffer_load_dwordx4 v[20:23], v10, s[8:11], 0 offen offset:256
s_waitcnt vmcnt(0)
v_accvgpr_write_b32 a36, v20
v_accvgpr_write_b32 a37, v21
v_accvgpr_write_b32 a38, v22
v_accvgpr_write_b32 a39, v23
v_add_u32 v10, 32, v6
v_add_u32 v10, s43, v10
v_mul_u32_u24 v10, 1280, v10
v_mul_u32_u24 v11, 320, v1
v_add_u32 v10, v10, v11
v_lshl_add_u32 v10, v7, 4, v10
v_add_u32 v10, 2621440, v10
buffer_load_dwordx4 v[20:23], v10, s[8:11], 0 offen offset:0
s_waitcnt vmcnt(0)
v_accvgpr_write_b32 a40, v20
v_accvgpr_write_b32 a41, v21
v_accvgpr_write_b32 a42, v22
v_accvgpr_write_b32 a43, v23
buffer_load_dwordx4 v[20:23], v10, s[8:11], 0 offen offset:64
s_waitcnt vmcnt(0)
v_accvgpr_write_b32 a44, v20
v_accvgpr_write_b32 a45, v21
v_accvgpr_write_b32 a46, v22
v_accvgpr_write_b32 a47, v23
buffer_load_dwordx4 v[20:23], v10, s[8:11], 0 offen offset:128
s_waitcnt vmcnt(0)
v_accvgpr_write_b32 a48, v20
v_accvgpr_write_b32 a49, v21
v_accvgpr_write_b32 a50, v22
v_accvgpr_write_b32 a51, v23
buffer_load_dwordx4 v[20:23], v10, s[8:11], 0 offen offset:192
s_waitcnt vmcnt(0)
v_accvgpr_write_b32 a52, v20
v_accvgpr_write_b32 a53, v21
v_accvgpr_write_b32 a54, v22
v_accvgpr_write_b32 a55, v23
buffer_load_dwordx4 v[20:23], v10, s[8:11], 0 offen offset:256
s_waitcnt vmcnt(0)
v_accvgpr_write_b32 a56, v20
v_accvgpr_write_b32 a57, v21
v_accvgpr_write_b32 a58, v22
v_accvgpr_write_b32 a59, v23
v_add_u32 v10, 6144, v6
v_add_u32 v10, s43, v10
v_mul_u32_u24 v10, 1280, v10
v_mul_u32_u24 v11, 320, v1
v_add_u32 v10, v10, v11
v_lshl_add_u32 v10, v7, 4, v10
v_add_u32 v10, 2621440, v10
buffer_load_dwordx4 v[20:23], v10, s[8:11], 0 offen offset:0
s_waitcnt vmcnt(0)
v_accvgpr_write_b32 a60, v20
v_accvgpr_write_b32 a61, v21
v_accvgpr_write_b32 a62, v22
v_accvgpr_write_b32 a63, v23
buffer_load_dwordx4 v[20:23], v10, s[8:11], 0 offen offset:64
s_waitcnt vmcnt(0)
v_accvgpr_write_b32 a64, v20
v_accvgpr_write_b32 a65, v21
v_accvgpr_write_b32 a66, v22
v_accvgpr_write_b32 a67, v23
buffer_load_dwordx4 v[20:23], v10, s[8:11], 0 offen offset:128
s_waitcnt vmcnt(0)
v_accvgpr_write_b32 a68, v20
v_accvgpr_write_b32 a69, v21
v_accvgpr_write_b32 a70, v22
v_accvgpr_write_b32 a71, v23
buffer_load_dwordx4 v[20:23], v10, s[8:11], 0 offen offset:192
s_waitcnt vmcnt(0)
v_accvgpr_write_b32 a72, v20
v_accvgpr_write_b32 a73, v21
v_accvgpr_write_b32 a74, v22
v_accvgpr_write_b32 a75, v23
buffer_load_dwordx4 v[20:23], v10, s[8:11], 0 offen offset:256
s_waitcnt vmcnt(0)
v_accvgpr_write_b32 a76, v20
v_accvgpr_write_b32 a77, v21
v_accvgpr_write_b32 a78, v22
v_accvgpr_write_b32 a79, v23
v_add_u32 v10, 6160, v6
v_add_u32 v10, s43, v10
v_mul_u32_u24 v10, 1280, v10
v_mul_u32_u24 v11, 320, v1
v_add_u32 v10, v10, v11
v_lshl_add_u32 v10, v7, 4, v10
v_add_u32 v10, 2621440, v10
buffer_load_dwordx4 v[20:23], v10, s[8:11], 0 offen offset:0
s_waitcnt vmcnt(0)
v_accvgpr_write_b32 a80, v20
v_accvgpr_write_b32 a81, v21
v_accvgpr_write_b32 a82, v22
v_accvgpr_write_b32 a83, v23
buffer_load_dwordx4 v[20:23], v10, s[8:11], 0 offen offset:64
s_waitcnt vmcnt(0)
v_accvgpr_write_b32 a84, v20
v_accvgpr_write_b32 a85, v21
v_accvgpr_write_b32 a86, v22
v_accvgpr_write_b32 a87, v23
buffer_load_dwordx4 v[20:23], v10, s[8:11], 0 offen offset:128
s_waitcnt vmcnt(0)
v_accvgpr_write_b32 a88, v20
v_accvgpr_write_b32 a89, v21
v_accvgpr_write_b32 a90, v22
v_accvgpr_write_b32 a91, v23
buffer_load_dwordx4 v[20:23], v10, s[8:11], 0 offen offset:192
s_waitcnt vmcnt(0)
v_accvgpr_write_b32 a92, v20
v_accvgpr_write_b32 a93, v21
v_accvgpr_write_b32 a94, v22
v_accvgpr_write_b32 a95, v23
buffer_load_dwordx4 v[20:23], v10, s[8:11], 0 offen offset:256
s_waitcnt vmcnt(0)
v_accvgpr_write_b32 a96, v20
v_accvgpr_write_b32 a97, v21
v_accvgpr_write_b32 a98, v22
v_accvgpr_write_b32 a99, v23
v_add_u32 v10, 6176, v6
v_add_u32 v10, s43, v10
v_mul_u32_u24 v10, 1280, v10
v_mul_u32_u24 v11, 320, v1
v_add_u32 v10, v10, v11
v_lshl_add_u32 v10, v7, 4, v10
v_add_u32 v10, 2621440, v10
buffer_load_dwordx4 v[20:23], v10, s[8:11], 0 offen offset:0
s_waitcnt vmcnt(0)
v_accvgpr_write_b32 a100, v20
v_accvgpr_write_b32 a101, v21
v_accvgpr_write_b32 a102, v22
v_accvgpr_write_b32 a103, v23
buffer_load_dwordx4 v[20:23], v10, s[8:11], 0 offen offset:64
s_waitcnt vmcnt(0)
v_accvgpr_write_b32 a104, v20
v_accvgpr_write_b32 a105, v21
v_accvgpr_write_b32 a106, v22
v_accvgpr_write_b32 a107, v23
buffer_load_dwordx4 v[20:23], v10, s[8:11], 0 offen offset:128
s_waitcnt vmcnt(0)
v_accvgpr_write_b32 a108, v20
v_accvgpr_write_b32 a109, v21
v_accvgpr_write_b32 a110, v22
v_accvgpr_write_b32 a111, v23
buffer_load_dwordx4 v[20:23], v10, s[8:11], 0 offen offset:192
s_waitcnt vmcnt(0)
v_accvgpr_write_b32 a112, v20
v_accvgpr_write_b32 a113, v21
v_accvgpr_write_b32 a114, v22
v_accvgpr_write_b32 a115, v23
buffer_load_dwordx4 v[20:23], v10, s[8:11], 0 offen offset:256
s_waitcnt vmcnt(0)
v_accvgpr_write_b32 a116, v20
v_accvgpr_write_b32 a117, v21
v_accvgpr_write_b32 a118, v22
v_accvgpr_write_b32 a119, v23
v_add_u32 v10, 12288, v6
v_add_u32 v10, s43, v10
v_mul_u32_u24 v10, 1280, v10
v_mul_u32_u24 v11, 320, v1
v_add_u32 v10, v10, v11
v_lshl_add_u32 v10, v7, 4, v10
v_add_u32 v10, 2621440, v10
buffer_load_dwordx4 v[20:23], v10, s[8:11], 0 offen offset:0
s_waitcnt vmcnt(0)
v_accvgpr_write_b32 a120, v20
v_accvgpr_write_b32 a121, v21
v_accvgpr_write_b32 a122, v22
v_accvgpr_write_b32 a123, v23
buffer_load_dwordx4 v[20:23], v10, s[8:11], 0 offen offset:64
s_waitcnt vmcnt(0)
v_accvgpr_write_b32 a124, v20
v_accvgpr_write_b32 a125, v21
v_accvgpr_write_b32 a126, v22
v_accvgpr_write_b32 a127, v23
buffer_load_dwordx4 v[20:23], v10, s[8:11], 0 offen offset:128
s_waitcnt vmcnt(0)
v_accvgpr_write_b32 a128, v20
v_accvgpr_write_b32 a129, v21
v_accvgpr_write_b32 a130, v22
v_accvgpr_write_b32 a131, v23
buffer_load_dwordx4 v[20:23], v10, s[8:11], 0 offen offset:192
s_waitcnt vmcnt(0)
v_accvgpr_write_b32 a132, v20
v_accvgpr_write_b32 a133, v21
v_accvgpr_write_b32 a134, v22
v_accvgpr_write_b32 a135, v23
buffer_load_dwordx4 v[20:23], v10, s[8:11], 0 offen offset:256
s_waitcnt vmcnt(0)
v_accvgpr_write_b32 a136, v20
v_accvgpr_write_b32 a137, v21
v_accvgpr_write_b32 a138, v22
v_accvgpr_write_b32 a139, v23
v_add_u32 v10, 12304, v6
v_add_u32 v10, s43, v10
v_mul_u32_u24 v10, 1280, v10
v_mul_u32_u24 v11, 320, v1
v_add_u32 v10, v10, v11
v_lshl_add_u32 v10, v7, 4, v10
v_add_u32 v10, 2621440, v10
buffer_load_dwordx4 v[20:23], v10, s[8:11], 0 offen offset:0
s_waitcnt vmcnt(0)
v_accvgpr_write_b32 a140, v20
v_accvgpr_write_b32 a141, v21
v_accvgpr_write_b32 a142, v22
v_accvgpr_write_b32 a143, v23
buffer_load_dwordx4 v[20:23], v10, s[8:11], 0 offen offset:64
s_waitcnt vmcnt(0)
v_accvgpr_write_b32 a144, v20
v_accvgpr_write_b32 a145, v21
v_accvgpr_write_b32 a146, v22
v_accvgpr_write_b32 a147, v23
buffer_load_dwordx4 v[20:23], v10, s[8:11], 0 offen offset:128
s_waitcnt vmcnt(0)
v_accvgpr_write_b32 a148, v20
v_accvgpr_write_b32 a149, v21
v_accvgpr_write_b32 a150, v22
v_accvgpr_write_b32 a151, v23
buffer_load_dwordx4 v[20:23], v10, s[8:11], 0 offen offset:192
s_waitcnt vmcnt(0)
v_accvgpr_write_b32 a152, v20
v_accvgpr_write_b32 a153, v21
v_accvgpr_write_b32 a154, v22
v_accvgpr_write_b32 a155, v23
buffer_load_dwordx4 v[20:23], v10, s[8:11], 0 offen offset:256
s_waitcnt vmcnt(0)
v_accvgpr_write_b32 a156, v20
v_accvgpr_write_b32 a157, v21
v_accvgpr_write_b32 a158, v22
v_accvgpr_write_b32 a159, v23
v_add_u32 v10, 12320, v6
v_add_u32 v10, s43, v10
v_mul_u32_u24 v10, 1280, v10
v_mul_u32_u24 v11, 320, v1
v_add_u32 v10, v10, v11
v_lshl_add_u32 v10, v7, 4, v10
v_add_u32 v10, 2621440, v10
buffer_load_dwordx4 v[20:23], v10, s[8:11], 0 offen offset:0
s_waitcnt vmcnt(0)
v_accvgpr_write_b32 a160, v20
v_accvgpr_write_b32 a161, v21
v_accvgpr_write_b32 a162, v22
v_accvgpr_write_b32 a163, v23
buffer_load_dwordx4 v[20:23], v10, s[8:11], 0 offen offset:64
s_waitcnt vmcnt(0)
v_accvgpr_write_b32 a164, v20
v_accvgpr_write_b32 a165, v21
v_accvgpr_write_b32 a166, v22
v_accvgpr_write_b32 a167, v23
buffer_load_dwordx4 v[20:23], v10, s[8:11], 0 offen offset:128
s_waitcnt vmcnt(0)
v_accvgpr_write_b32 a168, v20
v_accvgpr_write_b32 a169, v21
v_accvgpr_write_b32 a170, v22
v_accvgpr_write_b32 a171, v23
buffer_load_dwordx4 v[20:23], v10, s[8:11], 0 offen offset:192
s_waitcnt vmcnt(0)
v_accvgpr_write_b32 a172, v20
v_accvgpr_write_b32 a173, v21
v_accvgpr_write_b32 a174, v22
v_accvgpr_write_b32 a175, v23
buffer_load_dwordx4 v[20:23], v10, s[8:11], 0 offen offset:256
s_waitcnt vmcnt(0)
v_accvgpr_write_b32 a176, v20
v_accvgpr_write_b32 a177, v21
v_accvgpr_write_b32 a178, v22
v_accvgpr_write_b32 a179, v23
v_mul_u32_u24 v10, 160, v1
v_add_u32 v10, v10, v6
v_add_u32 v10, 0, v10
v_mul_u32_u24 v10, 12288, v10
v_add_u32 v10, 26214400, v10
s_lshl_b32 s44, s43, 1
v_add_u32 v10, s44, v10
v_lshl_add_u32 v11, v7, 4, v10
v_lshl_add_u32 v12, v7, 3, v10
buffer_load_dwordx4 v[20:23], v11, s[8:11], 0 offen
buffer_load_dwordx2 v[24:25], v12, s[8:11], 0 offen offset:64
s_waitcnt vmcnt(0)
v_accvgpr_write_b32 a180, v20
v_accvgpr_write_b32 a181, v21
v_accvgpr_write_b32 a182, v22
v_accvgpr_write_b32 a183, v23
v_accvgpr_write_b32 a184, v24
v_accvgpr_write_b32 a185, v25
v_mul_u32_u24 v10, 160, v1
v_add_u32 v10, v10, v6
v_add_u32 v10, 16, v10
v_mul_u32_u24 v10, 12288, v10
v_add_u32 v10, 26214400, v10
s_lshl_b32 s44, s43, 1
v_add_u32 v10, s44, v10
v_lshl_add_u32 v11, v7, 4, v10
v_lshl_add_u32 v12, v7, 3, v10
buffer_load_dwordx4 v[20:23], v11, s[8:11], 0 offen
buffer_load_dwordx2 v[24:25], v12, s[8:11], 0 offen offset:64
s_waitcnt vmcnt(0)
v_accvgpr_write_b32 a186, v20
v_accvgpr_write_b32 a187, v21
v_accvgpr_write_b32 a188, v22
v_accvgpr_write_b32 a189, v23
v_accvgpr_write_b32 a190, v24
v_accvgpr_write_b32 a191, v25
v_mul_u32_u24 v10, 160, v1
v_add_u32 v10, v10, v6
v_add_u32 v10, 32, v10
v_mul_u32_u24 v10, 12288, v10
v_add_u32 v10, 26214400, v10
s_lshl_b32 s44, s43, 1
v_add_u32 v10, s44, v10
v_lshl_add_u32 v11, v7, 4, v10
v_lshl_add_u32 v12, v7, 3, v10
buffer_load_dwordx4 v[20:23], v11, s[8:11], 0 offen
buffer_load_dwordx2 v[24:25], v12, s[8:11], 0 offen offset:64
s_waitcnt vmcnt(0)
v_accvgpr_write_b32 a192, v20
v_accvgpr_write_b32 a193, v21
v_accvgpr_write_b32 a194, v22
v_accvgpr_write_b32 a195, v23
v_accvgpr_write_b32 a196, v24
v_accvgpr_write_b32 a197, v25
v_mul_u32_u24 v10, 160, v1
v_add_u32 v10, v10, v6
v_add_u32 v10, 48, v10
v_mul_u32_u24 v10, 12288, v10
v_add_u32 v10, 26214400, v10
s_lshl_b32 s44, s43, 1
v_add_u32 v10, s44, v10
v_lshl_add_u32 v11, v7, 4, v10
v_lshl_add_u32 v12, v7, 3, v10
buffer_load_dwordx4 v[20:23], v11, s[8:11], 0 offen
buffer_load_dwordx2 v[24:25], v12, s[8:11], 0 offen offset:64
s_waitcnt vmcnt(0)
v_accvgpr_write_b32 a198, v20
v_accvgpr_write_b32 a199, v21
v_accvgpr_write_b32 a200, v22
v_accvgpr_write_b32 a201, v23
v_accvgpr_write_b32 a202, v24
v_accvgpr_write_b32 a203, v25
v_mul_u32_u24 v10, 160, v1
v_add_u32 v10, v10, v6
v_add_u32 v10, 64, v10
v_mul_u32_u24 v10, 12288, v10
v_add_u32 v10, 26214400, v10
s_lshl_b32 s44, s43, 1
v_add_u32 v10, s44, v10
v_lshl_add_u32 v11, v7, 4, v10
v_lshl_add_u32 v12, v7, 3, v10
buffer_load_dwordx4 v[20:23], v11, s[8:11], 0 offen
buffer_load_dwordx2 v[24:25], v12, s[8:11], 0 offen offset:64
s_waitcnt vmcnt(0)
v_accvgpr_write_b32 a204, v20
v_accvgpr_write_b32 a205, v21
v_accvgpr_write_b32 a206, v22
v_accvgpr_write_b32 a207, v23
v_accvgpr_write_b32 a208, v24
v_accvgpr_write_b32 a209, v25
v_mul_u32_u24 v10, 160, v1
v_add_u32 v10, v10, v6
v_add_u32 v10, 80, v10
v_mul_u32_u24 v10, 12288, v10
v_add_u32 v10, 26214400, v10
s_lshl_b32 s44, s43, 1
v_add_u32 v10, s44, v10
v_lshl_add_u32 v11, v7, 4, v10
v_lshl_add_u32 v12, v7, 3, v10
buffer_load_dwordx4 v[20:23], v11, s[8:11], 0 offen
buffer_load_dwordx2 v[24:25], v12, s[8:11], 0 offen offset:64
s_waitcnt vmcnt(0)
v_accvgpr_write_b32 a210, v20
v_accvgpr_write_b32 a211, v21
v_accvgpr_write_b32 a212, v22
v_accvgpr_write_b32 a213, v23
v_accvgpr_write_b32 a214, v24
v_accvgpr_write_b32 a215, v25
v_mul_u32_u24 v10, 160, v1
v_add_u32 v10, v10, v6
v_add_u32 v10, 96, v10
v_mul_u32_u24 v10, 12288, v10
v_add_u32 v10, 26214400, v10
s_lshl_b32 s44, s43, 1
v_add_u32 v10, s44, v10
v_lshl_add_u32 v11, v7, 4, v10
v_lshl_add_u32 v12, v7, 3, v10
buffer_load_dwordx4 v[20:23], v11, s[8:11], 0 offen
buffer_load_dwordx2 v[24:25], v12, s[8:11], 0 offen offset:64
s_waitcnt vmcnt(0)
v_accvgpr_write_b32 a216, v20
v_accvgpr_write_b32 a217, v21
v_accvgpr_write_b32 a218, v22
v_accvgpr_write_b32 a219, v23
v_accvgpr_write_b32 a220, v24
v_accvgpr_write_b32 a221, v25
v_mul_u32_u24 v10, 160, v1
v_add_u32 v10, v10, v6
v_add_u32 v10, 112, v10
v_mul_u32_u24 v10, 12288, v10
v_add_u32 v10, 26214400, v10
s_lshl_b32 s44, s43, 1
v_add_u32 v10, s44, v10
v_lshl_add_u32 v11, v7, 4, v10
v_lshl_add_u32 v12, v7, 3, v10
buffer_load_dwordx4 v[20:23], v11, s[8:11], 0 offen
buffer_load_dwordx2 v[24:25], v12, s[8:11], 0 offen offset:64
s_waitcnt vmcnt(0)
v_accvgpr_write_b32 a222, v20
v_accvgpr_write_b32 a223, v21
v_accvgpr_write_b32 a224, v22
v_accvgpr_write_b32 a225, v23
v_accvgpr_write_b32 a226, v24
v_accvgpr_write_b32 a227, v25
v_mul_u32_u24 v10, 160, v1
v_add_u32 v10, v10, v6
v_add_u32 v10, 128, v10
v_mul_u32_u24 v10, 12288, v10
v_add_u32 v10, 26214400, v10
s_lshl_b32 s44, s43, 1
v_add_u32 v10, s44, v10
v_lshl_add_u32 v11, v7, 4, v10
v_lshl_add_u32 v12, v7, 3, v10
buffer_load_dwordx4 v[20:23], v11, s[8:11], 0 offen
buffer_load_dwordx2 v[24:25], v12, s[8:11], 0 offen offset:64
s_waitcnt vmcnt(0)
v_accvgpr_write_b32 a228, v20
v_accvgpr_write_b32 a229, v21
v_accvgpr_write_b32 a230, v22
v_accvgpr_write_b32 a231, v23
v_accvgpr_write_b32 a232, v24
v_accvgpr_write_b32 a233, v25
v_mul_u32_u24 v10, 160, v1
v_add_u32 v10, v10, v6
v_add_u32 v10, 144, v10
v_mul_u32_u24 v10, 12288, v10
v_add_u32 v10, 26214400, v10
s_lshl_b32 s44, s43, 1
v_add_u32 v10, s44, v10
v_lshl_add_u32 v11, v7, 4, v10
v_lshl_add_u32 v12, v7, 3, v10
buffer_load_dwordx4 v[20:23], v11, s[8:11], 0 offen
buffer_load_dwordx2 v[24:25], v12, s[8:11], 0 offen offset:64
s_waitcnt vmcnt(0)
v_accvgpr_write_b32 a234, v20
v_accvgpr_write_b32 a235, v21
v_accvgpr_write_b32 a236, v22
v_accvgpr_write_b32 a237, v23
v_accvgpr_write_b32 a238, v24
v_accvgpr_write_b32 a239, v25
s_mov_b32 s40, 0
ch_kernel_s:
s_cmp_lg_u32 s40, 0
s_cbranch_scc1 ch_kernel_p
v_add_u32 v10, 0, v0
v_lshrrev_b32 v11, 1, v10
v_and_b32 v12, 1, v10
v_lshl_add_u32 v12, v12, 2, 0
v_mul_u32_u24 v12, 640, v12
v_add_lshl_u32 v12, v12, v11, 1
buffer_load_ushort v13, v12, s[12:15], 0 offen
s_waitcnt vmcnt(0)
v_lshlrev_b32 v20, 16, v13
v_add_u32 v10, 0, v0
v_lshrrev_b32 v11, 1, v10
v_and_b32 v12, 1, v10
v_lshl_add_u32 v12, v12, 2, 1
v_mul_u32_u24 v12, 640, v12
v_add_lshl_u32 v12, v12, v11, 1
buffer_load_ushort v13, v12, s[12:15], 0 offen
s_waitcnt vmcnt(0)
v_lshlrev_b32 v21, 16, v13
v_add_u32 v10, 0, v0
v_lshrrev_b32 v11, 1, v10
v_and_b32 v12, 1, v10
v_lshl_add_u32 v12, v12, 2, 2
v_mul_u32_u24 v12, 640, v12
v_add_lshl_u32 v12, v12, v11, 1
buffer_load_ushort v13, v12, s[12:15], 0 offen
s_waitcnt vmcnt(0)
v_lshlrev_b32 v22, 16, v13
v_add_u32 v10, 0, v0
v_lshrrev_b32 v11, 1, v10
v_and_b32 v12, 1, v10
v_lshl_add_u32 v12, v12, 2, 3
v_mul_u32_u24 v12, 640, v12
v_add_lshl_u32 v12, v12, v11, 1
buffer_load_ushort v13, v12, s[12:15], 0 offen
s_waitcnt vmcnt(0)
v_lshlrev_b32 v23, 16, v13
v_add_u32 v10, 256, v0
v_lshrrev_b32 v11, 1, v10
v_and_b32 v12, 1, v10
v_lshl_add_u32 v12, v12, 2, 0
v_mul_u32_u24 v12, 640, v12
v_add_lshl_u32 v12, v12, v11, 1
buffer_load_ushort v13, v12, s[12:15], 0 offen
s_waitcnt vmcnt(0)
v_lshlrev_b32 v24, 16, v13
v_add_u32 v10, 256, v0
v_lshrrev_b32 v11, 1, v10
v_and_b32 v12, 1, v10
v_lshl_add_u32 v12, v12, 2, 1
v_mul_u32_u24 v12, 640, v12
v_add_lshl_u32 v12, v12, v11, 1
buffer_load_ushort v13, v12, s[12:15], 0 offen
s_waitcnt vmcnt(0)
v_lshlrev_b32 v25, 16, v13
v_add_u32 v10, 256, v0
v_lshrrev_b32 v11, 1, v10
v_and_b32 v12, 1, v10
v_lshl_add_u32 v12, v12, 2, 2
v_mul_u32_u24 v12, 640, v12
v_add_lshl_u32 v12, v12, v11, 1
buffer_load_ushort v13, v12, s[12:15], 0 offen
s_waitcnt vmcnt(0)
v_lshlrev_b32 v26, 16, v13
v_add_u32 v10, 256, v0
v_lshrrev_b32 v11, 1, v10
v_and_b32 v12, 1, v10
v_lshl_add_u32 v12, v12, 2, 3
v_mul_u32_u24 v12, 640, v12
v_add_lshl_u32 v12, v12, v11, 1
buffer_load_ushort v13, v12, s[12:15], 0 offen
s_waitcnt vmcnt(0)
v_lshlrev_b32 v27, 16, v13
v_add_u32 v10, 512, v0
v_lshrrev_b32 v11, 1, v10
v_and_b32 v12, 1, v10
v_lshl_add_u32 v12, v12, 2, 0
v_mul_u32_u24 v12, 640, v12
v_add_lshl_u32 v12, v12, v11, 1
buffer_load_ushort v13, v12, s[12:15], 0 offen
s_waitcnt vmcnt(0)
v_lshlrev_b32 v28, 16, v13
v_add_u32 v10, 512, v0
v_lshrrev_b32 v11, 1, v10
v_and_b32 v12, 1, v10
v_lshl_add_u32 v12, v12, 2, 1
v_mul_u32_u24 v12, 640, v12
v_add_lshl_u32 v12, v12, v11, 1
buffer_load_ushort v13, v12, s[12:15], 0 offen
s_waitcnt vmcnt(0)
v_lshlrev_b32 v29, 16, v13
v_add_u32 v10, 512, v0
v_lshrrev_b32 v11, 1, v10
v_and_b32 v12, 1, v10
v_lshl_add_u32 v12, v12, 2, 2
v_mul_u32_u24 v12, 640, v12
v_add_lshl_u32 v12, v12, v11, 1
buffer_load_ushort v13, v12, s[12:15], 0 offen
s_waitcnt vmcnt(0)
v_lshlrev_b32 v30, 16, v13
v_add_u32 v10, 512, v0
v_lshrrev_b32 v11, 1, v10
v_and_b32 v12, 1, v10
v_lshl_add_u32 v12, v12, 2, 3
v_mul_u32_u24 v12, 640, v12
v_add_lshl_u32 v12, v12, v11, 1
buffer_load_ushort v13, v12, s[12:15], 0 offen
s_waitcnt vmcnt(0)
v_lshlrev_b32 v31, 16, v13
v_add_u32 v10, 768, v0
v_lshrrev_b32 v11, 1, v10
v_and_b32 v12, 1, v10
v_lshl_add_u32 v12, v12, 2, 0
v_mul_u32_u24 v12, 640, v12
v_add_lshl_u32 v12, v12, v11, 1
buffer_load_ushort v13, v12, s[12:15], 0 offen
s_waitcnt vmcnt(0)
v_lshlrev_b32 v32, 16, v13
v_add_u32 v10, 768, v0
v_lshrrev_b32 v11, 1, v10
v_and_b32 v12, 1, v10
v_lshl_add_u32 v12, v12, 2, 1
v_mul_u32_u24 v12, 640, v12
v_add_lshl_u32 v12, v12, v11, 1
buffer_load_ushort v13, v12, s[12:15], 0 offen
s_waitcnt vmcnt(0)
v_lshlrev_b32 v33, 16, v13
v_add_u32 v10, 768, v0
v_lshrrev_b32 v11, 1, v10
v_and_b32 v12, 1, v10
v_lshl_add_u32 v12, v12, 2, 2
v_mul_u32_u24 v12, 640, v12
v_add_lshl_u32 v12, v12, v11, 1
buffer_load_ushort v13, v12, s[12:15], 0 offen
s_waitcnt vmcnt(0)
v_lshlrev_b32 v34, 16, v13
v_add_u32 v10, 768, v0
v_lshrrev_b32 v11, 1, v10
v_and_b32 v12, 1, v10
v_lshl_add_u32 v12, v12, 2, 3
v_mul_u32_u24 v12, 640, v12
v_add_lshl_u32 v12, v12, v11, 1
buffer_load_ushort v13, v12, s[12:15], 0 offen
s_waitcnt vmcnt(0)
v_lshlrev_b32 v35, 16, v13
v_add_u32 v10, 1024, v0
v_lshrrev_b32 v11, 1, v10
v_and_b32 v12, 1, v10
v_lshl_add_u32 v12, v12, 2, 0
v_mul_u32_u24 v12, 640, v12
v_add_lshl_u32 v12, v12, v11, 1
buffer_load_ushort v13, v12, s[12:15], 0 offen
s_waitcnt vmcnt(0)
v_lshlrev_b32 v36, 16, v13
v_add_u32 v10, 1024, v0
v_lshrrev_b32 v11, 1, v10
v_and_b32 v12, 1, v10
v_lshl_add_u32 v12, v12, 2, 1
v_mul_u32_u24 v12, 640, v12
v_add_lshl_u32 v12, v12, v11, 1
buffer_load_ushort v13, v12, s[12:15], 0 offen
s_waitcnt vmcnt(0)
v_lshlrev_b32 v37, 16, v13
v_add_u32 v10, 1024, v0
v_lshrrev_b32 v11, 1, v10
v_and_b32 v12, 1, v10
v_lshl_add_u32 v12, v12, 2, 2
v_mul_u32_u24 v12, 640, v12
v_add_lshl_u32 v12, v12, v11, 1
buffer_load_ushort v13, v12, s[12:15], 0 offen
s_waitcnt vmcnt(0)
v_lshlrev_b32 v38, 16, v13
v_add_u32 v10, 1024, v0
v_lshrrev_b32 v11, 1, v10
v_and_b32 v12, 1, v10
v_lshl_add_u32 v12, v12, 2, 3
v_mul_u32_u24 v12, 640, v12
v_add_lshl_u32 v12, v12, v11, 1
buffer_load_ushort v13, v12, s[12:15], 0 offen
s_waitcnt vmcnt(0)
v_lshlrev_b32 v39, 16, v13
s_branch ch_kernel_m
ch_kernel_p:
s_sub_u32 s40, s40, 1
ch_kernel_p1:
v_lshlrev_b32 v10, 4, v0
v_add_u32 v10, 162791424, v10
buffer_load_dwordx4 v[20:23], v10, s[8:11], 0 offen sc1
v_lshlrev_b32 v10, 4, v0
v_add_u32 v10, 162795520, v10
buffer_load_dwordx4 v[24:27], v10, s[8:11], 0 offen sc1
v_lshlrev_b32 v10, 4, v0
v_add_u32 v10, 162799616, v10
buffer_load_dwordx4 v[28:31], v10, s[8:11], 0 offen sc1
v_lshlrev_b32 v10, 4, v0
v_add_u32 v10, 162803712, v10
buffer_load_dwordx4 v[32:35], v10, s[8:11], 0 offen sc1
v_lshlrev_b32 v10, 4, v0
v_add_u32 v10, 162807808, v10
buffer_load_dwordx4 v[36:39], v10, s[8:11], 0 offen sc1
s_waitcnt vmcnt(0)
v_mov_b32 v60, 0
v_xor_b32 v61, s40, v20
v_and_b32 v61, 63, v61
v_or_b32 v60, v60, v61
v_xor_b32 v61, s40, v21
v_and_b32 v61, 63, v61
v_or_b32 v60, v60, v61
v_xor_b32 v61, s40, v22
v_and_b32 v61, 63, v61
v_or_b32 v60, v60, v61
v_xor_b32 v61, s40, v23
v_and_b32 v61, 63, v61
v_or_b32 v60, v60, v61
v_xor_b32 v61, s40, v24
v_and_b32 v61, 63, v61
v_or_b32 v60, v60, v61
v_xor_b32 v61, s40, v25
v_and_b32 v61, 63, v61
v_or_b32 v60, v60, v61
v_xor_b32 v61, s40, v26
v_and_b32 v61, 63, v61
v_or_b32 v60, v60, v61
v_xor_b32 v61, s40, v27
v_and_b32 v61, 63, v61
v_or_b32 v60, v60, v61
v_xor_b32 v61, s40, v28
v_and_b32 v61, 63, v61
v_or_b32 v60, v60, v61
v_xor_b32 v61, s40, v29
v_and_b32 v61, 63, v61
v_or_b32 v60, v60, v61
v_xor_b32 v61, s40, v30
v_and_b32 v61, 63, v61
v_or_b32 v60, v60, v61
v_xor_b32 v61, s40, v31
v_and_b32 v61, 63, v61
v_or_b32 v60, v60, v61
v_xor_b32 v61, s40, v32
v_and_b32 v61, 63, v61
v_or_b32 v60, v60, v61
v_xor_b32 v61, s40, v33
v_and_b32 v61, 63, v61
v_or_b32 v60, v60, v61
v_xor_b32 v61, s40, v34
v_and_b32 v61, 63, v61
v_or_b32 v60, v60, v61
v_xor_b32 v61, s40, v35
v_and_b32 v61, 63, v61
v_or_b32 v60, v60, v61
v_xor_b32 v61, s40, v36
v_and_b32 v61, 63, v61
v_or_b32 v60, v60, v61
v_xor_b32 v61, s40, v37
v_and_b32 v61, 63, v61
v_or_b32 v60, v60, v61
v_xor_b32 v61, s40, v38
v_and_b32 v61, 63, v61
v_or_b32 v60, v60, v61
v_xor_b32 v61, s40, v39
v_and_b32 v61, 63, v61
v_or_b32 v60, v60, v61
v_cmp_ne_u32 vcc, 0, v60
s_cbranch_vccnz ch_kernel_p1
s_add_u32 s40, s40, 1
ch_kernel_m:
v_add_u32 v10, 0, v0
v_lshrrev_b32 v11, 1, v10
v_and_b32 v12, 1, v10
v_mul_u32_u24 v12, 5184, v12
v_lshl_add_u32 v12, v11, 1, v12
ds_write_b16_d16_hi v12, v20 offset:0
ds_write_b16_d16_hi v12, v21 offset:1296
ds_write_b16_d16_hi v12, v22 offset:2592
ds_write_b16_d16_hi v12, v23 offset:3888
v_add_u32 v10, 256, v0
v_lshrrev_b32 v11, 1, v10
v_and_b32 v12, 1, v10
v_mul_u32_u24 v12, 5184, v12
v_lshl_add_u32 v12, v11, 1, v12
ds_write_b16_d16_hi v12, v24 offset:0
ds_write_b16_d16_hi v12, v25 offset:1296
ds_write_b16_d16_hi v12, v26 offset:2592
ds_write_b16_d16_hi v12, v27 offset:3888
v_add_u32 v10, 512, v0
v_lshrrev_b32 v11, 1, v10
v_and_b32 v12, 1, v10
v_mul_u32_u24 v12, 5184, v12
v_lshl_add_u32 v12, v11, 1, v12
ds_write_b16_d16_hi v12, v28 offset:0
ds_write_b16_d16_hi v12, v29 offset:1296
ds_write_b16_d16_hi v12, v30 offset:2592
ds_write_b16_d16_hi v12, v31 offset:3888
v_add_u32 v10, 768, v0
v_lshrrev_b32 v11, 1, v10
v_and_b32 v12, 1, v10
v_mul_u32_u24 v12, 5184, v12
v_lshl_add_u32 v12, v11, 1, v12
ds_write_b16_d16_hi v12, v32 offset:0
ds_write_b16_d16_hi v12, v33 offset:1296
ds_write_b16_d16_hi v12, v34 offset:2592
ds_write_b16_d16_hi v12, v35 offset:3888
v_add_u32 v10, 1024, v0
v_lshrrev_b32 v11, 1, v10
v_and_b32 v12, 1, v10
v_mul_u32_u24 v12, 5184, v12
v_lshl_add_u32 v12, v11, 1, v12
ds_write_b16_d16_hi v12, v36 offset:0
ds_write_b16_d16_hi v12, v37 offset:1296
ds_write_b16_d16_hi v12, v38 offset:2592
ds_write_b16_d16_hi v12, v39 offset:3888
s_lshl_b32 s45, s40, 5
v_add_u32 v10, s45, v6
v_add_u32 v10, 0, v10
v_mul_u32_u24 v10, 12288, v10
s_lshl_b32 s44, s43, 1
v_add_u32 v10, s44, v10
v_add_u32 v10, 63176704, v10
v_lshl_add_u32 v11, v7, 4, v10
v_lshl_add_u32 v12, v7, 3, v10
buffer_load_dwordx4 v[64:67], v11, s[8:11], 0 offen
buffer_load_dwordx2 v[76:77], v12, s[8:11], 0 offen offset:64
v_add_u32 v10, s43, v6
v_add_u32 v10, 0, v10
v_lshlrev_b32 v10, 12, v10
v_add_u32 v10, 88342528, v10
v_lshl_add_u32 v10, s45, 1, v10
v_max_u32 v11, 2, v7
v_lshl_add_u32 v11, v11, 4, v10
v_add_u32 v11, -32, v11
v_lshl_add_u32 v12, v7, 3, v10
buffer_load_dwordx4 v[82:85], v11, s[8:11], 0 offen
buffer_load_dwordx2 v[94:95], v12, s[8:11], 0 offen offset:32
v_add_u32 v10, s45, v6
v_add_u32 v10, 0, v10
v_mul_u32_u24 v10, 12288, v10
s_lshl_b32 s44, s43, 1
v_add_u32 v10, s44, v10
v_add_u32 v10, 63176704, v10
v_lshl_add_u32 v11, v7, 4, v10
v_lshl_add_u32 v12, v7, 3, v10
buffer_load_dwordx4 v[68:71], v11, s[8:11], 0 offen
buffer_load_dwordx2 v[78:79], v12, s[8:11], 0 offen offset:64
v_add_u32 v10, s43, v6
v_add_u32 v10, 16, v10
v_lshlrev_b32 v10, 12, v10
v_add_u32 v10, 88342528, v10
v_lshl_add_u32 v10, s45, 1, v10
v_max_u32 v11, 2, v7
v_lshl_add_u32 v11, v11, 4, v10
v_add_u32 v11, -32, v11
v_lshl_add_u32 v12, v7, 3, v10
buffer_load_dwordx4 v[86:89], v11, s[8:11], 0 offen
buffer_load_dwordx2 v[96:97], v12, s[8:11], 0 offen offset:32
v_add_u32 v10, s45, v6
v_add_u32 v10, 16, v10
v_mul_u32_u24 v10, 12288, v10
s_lshl_b32 s44, s43, 1
v_add_u32 v10, s44, v10
v_add_u32 v10, 63176704, v10
v_lshl_add_u32 v11, v7, 4, v10
v_lshl_add_u32 v12, v7, 3, v10
buffer_load_dwordx4 v[72:75], v11, s[8:11], 0 offen
buffer_load_dwordx2 v[80:81], v12, s[8:11], 0 offen offset:64
v_add_u32 v10, s43, v6
v_add_u32 v10, 32, v10
v_lshlrev_b32 v10, 12, v10
v_add_u32 v10, 88342528, v10
v_lshl_add_u32 v10, s45, 1, v10
v_max_u32 v11, 2, v7
v_lshl_add_u32 v11, v11, 4, v10
v_add_u32 v11, -32, v11
v_lshl_add_u32 v12, v7, 3, v10
buffer_load_dwordx4 v[90:93], v11, s[8:11], 0 offen
buffer_load_dwordx2 v[98:99], v12, s[8:11], 0 offen offset:32
s_waitcnt lgkmcnt(0)
s_barrier
v_and_b32 v10, 7, v6
v_mul_u32_u24 v10, 1296, v10
v_mul_u32_u24 v11, 320, v1
v_add_u32 v10, v10, v11
v_lshl_add_u32 v10, v7, 4, v10
ds_read_b128 v[20:23], v10 offset:0
ds_read_b128 v[24:27], v10 offset:64
ds_read_b128 v[28:31], v10 offset:128
ds_read_b128 v[32:35], v10 offset:192
ds_read_b128 v[36:39], v10 offset:256
s_waitcnt lgkmcnt(0)
v_mul_u32_u24 v11, 4608, v1
v_lshl_add_u32 v11, v2, 4, v11
v_mov_b32 v40, 0
v_mov_b32 v41, 0
v_mov_b32 v42, 0
v_mov_b32 v43, 0
s_nop 1
v_mfma_f32_16x16x32_bf16 v[40:43], v[20:23], a[0:3], v[40:43]
v_mfma_f32_16x16x32_bf16 v[40:43], v[24:27], a[4:7], v[40:43]
v_mfma_f32_16x16x32_bf16 v[40:43], v[28:31], a[8:11], v[40:43]
v_mfma_f32_16x16x32_bf16 v[40:43], v[32:35], a[12:15], v[40:43]
v_mfma_f32_16x16x32_bf16 v[40:43], v[36:39], a[16:19], v[40:43]
s_nop 7
v_cmp_gt_u32 vcc, 32, v2
s_and_saveexec_b64 s[46:47], vcc
ds_write_b128 v11, v[40:43] offset:10496
s_mov_b64 exec, s[46:47]
v_mov_b32 v40, 0
v_mov_b32 v41, 0
v_mov_b32 v42, 0
v_mov_b32 v43, 0
s_nop 1
v_mfma_f32_16x16x32_bf16 v[40:43], v[20:23], a[20:23], v[40:43]
v_mfma_f32_16x16x32_bf16 v[40:43], v[24:27], a[24:27], v[40:43]
v_mfma_f32_16x16x32_bf16 v[40:43], v[28:31], a[28:31], v[40:43]
v_mfma_f32_16x16x32_bf16 v[40:43], v[32:35], a[32:35], v[40:43]
v_mfma_f32_16x16x32_bf16 v[40:43], v[36:39], a[36:39], v[40:43]
s_nop 7
v_cmp_gt_u32 vcc, 32, v2
s_and_saveexec_b64 s[46:47], vcc
ds_write_b128 v11, v[40:43] offset:11008
s_mov_b64 exec, s[46:47]
v_mov_b32 v40, 0
v_mov_b32 v41, 0
v_mov_b32 v42, 0
v_mov_b32 v43, 0
s_nop 1
v_mfma_f32_16x16x32_bf16 v[40:43], v[20:23], a[40:43], v[40:43]
v_mfma_f32_16x16x32_bf16 v[40:43], v[24:27], a[44:47], v[40:43]
v_mfma_f32_16x16x32_bf16 v[40:43], v[28:31], a[48:51], v[40:43]
v_mfma_f32_16x16x32_bf16 v[40:43], v[32:35], a[52:55], v[40:43]
v_mfma_f32_16x16x32_bf16 v[40:43], v[36:39], a[56:59], v[40:43]
s_nop 7
v_cmp_gt_u32 vcc, 32, v2
s_and_saveexec_b64 s[46:47], vcc
ds_write_b128 v11, v[40:43] offset:11520
s_mov_b64 exec, s[46:47]
v_mov_b32 v40, 0
v_mov_b32 v41, 0
v_mov_b32 v42, 0
v_mov_b32 v43, 0
s_nop 1
v_mfma_f32_16x16x32_bf16 v[40:43], v[20:23], a[60:63], v[40:43]
v_mfma_f32_16x16x32_bf16 v[40:43], v[24:27], a[64:67], v[40:43]
v_mfma_f32_16x16x32_bf16 v[40:43], v[28:31], a[68:71], v[40:43]
v_mfma_f32_16x16x32_bf16 v[40:43], v[32:35], a[72:75], v[40:43]
v_mfma_f32_16x16x32_bf16 v[40:43], v[36:39], a[76:79], v[40:43]
s_nop 7
v_cmp_gt_u32 vcc, 32, v2
s_and_saveexec_b64 s[46:47], vcc
ds_write_b128 v11, v[40:43] offset:12032
s_mov_b64 exec, s[46:47]
v_mov_b32 v40, 0
v_mov_b32 v41, 0
v_mov_b32 v42, 0
v_mov_b32 v43, 0
s_nop 1
v_mfma_f32_16x16x32_bf16 v[40:43], v[20:23], a[80:83], v[40:43]
v_mfma_f32_16x16x32_bf16 v[40:43], v[24:27], a[84:87], v[40:43]
v_mfma_f32_16x16x32_bf16 v[40:43], v[28:31], a[88:91], v[40:43]
v_mfma_f32_16x16x32_bf16 v[40:43], v[32:35], a[92:95], v[40:43]
v_mfma_f32_16x16x32_bf16 v[40:43], v[36:39], a[96:99], v[40:43]
s_nop 7
v_cmp_gt_u32 vcc, 32, v2
s_and_saveexec_b64 s[46:47], vcc
ds_write_b128 v11, v[40:43] offset:12544
s_mov_b64 exec, s[46:47]
v_mov_b32 v40, 0
v_mov_b32 v41, 0
v_mov_b32 v42, 0
v_mov_b32 v43, 0
s_nop 1
v_mfma_f32_16x16x32_bf16 v[40:43], v[20:23], a[100:103], v[40:43]
v_mfma_f32_16x16x32_bf16 v[40:43], v[24:27], a[104:107], v[40:43]
v_mfma_f32_16x16x32_bf16 v[40:43], v[28:31], a[108:111], v[40:43]
v_mfma_f32_16x16x32_bf16 v[40:43], v[32:35], a[112:115], v[40:43]
v_mfma_f32_16x16x32_bf16 v[40:43], v[36:39], a[116:119], v[40:43]
s_nop 7
v_cmp_gt_u32 vcc, 32, v2
s_and_saveexec_b64 s[46:47], vcc
ds_write_b128 v11, v[40:43] offset:13056
s_mov_b64 exec, s[46:47]
v_mov_b32 v40, 0
v_mov_b32 v41, 0
v_mov_b32 v42, 0
v_mov_b32 v43, 0
s_nop 1
v_mfma_f32_16x16x32_bf16 v[40:43], v[20:23], a[120:123], v[40:43]
v_mfma_f32_16x16x32_bf16 v[40:43], v[24:27], a[124:127], v[40:43]
v_mfma_f32_16x16x32_bf16 v[40:43], v[28:31], a[128:131], v[40:43]
v_mfma_f32_16x16x32_bf16 v[40:43], v[32:35], a[132:135], v[40:43]
v_mfma_f32_16x16x32_bf16 v[40:43], v[36:39], a[136:139], v[40:43]
s_nop 7
v_cmp_gt_u32 vcc, 32, v2
s_and_saveexec_b64 s[46:47], vcc
ds_write_b128 v11, v[40:43] offset:13568
s_mov_b64 exec, s[46:47]
v_mov_b32 v40, 0
v_mov_b32 v41, 0
v_mov_b32 v42, 0
v_mov_b32 v43, 0
s_nop 1
v_mfma_f32_16x16x32_bf16 v[40:43], v[20:23], a[140:143], v[40:43]
v_mfma_f32_16x16x32_bf16 v[40:43], v[24:27], a[144:147], v[40:43]
v_mfma_f32_16x16x32_bf16 v[40:43], v[28:31], a[148:151], v[40:43]
v_mfma_f32_16x16x32_bf16 v[40:43], v[32:35], a[152:155], v[40:43]
v_mfma_f32_16x16x32_bf16 v[40:43], v[36:39], a[156:159], v[40:43]
s_nop 7
v_cmp_gt_u32 vcc, 32, v2
s_and_saveexec_b64 s[46:47], vcc
ds_write_b128 v11, v[40:43] offset:14080
s_mov_b64 exec, s[46:47]
v_mov_b32 v40, 0
v_mov_b32 v41, 0
v_mov_b32 v42, 0
v_mov_b32 v43, 0
s_nop 1
v_mfma_f32_16x16x32_bf16 v[40:43], v[20:23], a[160:163], v[40:43]
v_mfma_f32_16x16x32_bf16 v[40:43], v[24:27], a[164:167], v[40:43]
v_mfma_f32_16x16x32_bf16 v[40:43], v[28:31], a[168:171], v[40:43]
v_mfma_f32_16x16x32_bf16 v[40:43], v[32:35], a[172:175], v[40:43]
v_mfma_f32_16x16x32_bf16 v[40:43], v[36:39], a[176:179], v[40:43]
s_nop 7
v_cmp_gt_u32 vcc, 32, v2
s_and_saveexec_b64 s[46:47], vcc
ds_write_b128 v11, v[40:43] offset:14592
s_mov_b64 exec, s[46:47]
s_waitcnt lgkmcnt(0)
s_barrier
v_add_u32 v10, 0, v0
v_cmp_gt_u32 vcc, 288, v10
s_and_saveexec_b64 s[46:47], vcc
s_cbranch_execz ch_kernel_k0
v_lshlrev_b32 v11, 4, v10
ds_read_b128 v[20:23], v11 offset:10496
ds_read_b128 v[24:27], v11 offset:15104
ds_read_b128 v[28:31], v11 offset:19712
ds_read_b128 v[32:35], v11 offset:24320
s_waitcnt lgkmcnt(0)
v_add_f32 v20, v20, v24
v_add_f32 v28, v28, v32
v_add_f32 v20, v20, v28
v_add_f32 v21, v21, v25
v_add_f32 v29, v29, v33
v_add_f32 v21, v21, v29
v_add_f32 v22, v22, v26
v_add_f32 v30, v30, v34
v_add_f32 v22, v22, v30
v_add_f32 v23, v23, v27
v_add_f32 v31, v31, v35
v_add_f32 v23, v23, v31
v_cvt_pk_bf16_f32 v24, v20, v21
v_cvt_pk_bf16_f32 v25, v22, v23
v_lshrrev_b32 v12, 5, v10
v_and_b32 v13, 31, v10
v_cmp_lt_u32 vcc, 2, v12
v_cndmask_b32 v14, 0, 1, vcc
v_cmp_lt_u32 vcc, 5, v12
v_cndmask_b32 v15, 0, 1, vcc
v_add_u32 v14, v14, v15
v_mul_u32_u24 v15, 3, v14
v_sub_u32 v15, v12, v15
v_lshlrev_b32 v15, 4, v15
v_and_b32 v16, 15, v13
v_add_u32 v15, v15, v16
v_lshrrev_b32 v16, 4, v13
v_lshlrev_b32 v16, 2, v16
v_mul_u32_u24 v17, 896, v14
v_mul_u32_u24 v18, 112, v16
v_add_u32 v17, v17, v18
v_lshl_add_u32 v17, v15, 1, v17
ds_write_b16 v17, v24 offset:29184
ds_write_b16_d16_hi v17, v24 offset:29296
ds_write_b16 v17, v25 offset:29408
ds_write_b16_d16_hi v17, v25 offset:29520
v_lshlrev_b32 v17, 4, v15
v_lshl_add_u32 v17, v16, 1, v17
v_cmp_eq_u32 vcc, 2, v14
s_and_saveexec_b64 s[48:49], vcc
ds_write_b64 v17, v[24:25] offset:34560
v_add_u32 v18, s43, v15
s_mul_i32 s44, s40, 6144
v_add_u32 v18, s44, v18
v_lshl_add_u32 v18, v18, 3, v16
v_lshlrev_b32 v18, 1, v18
v_add_u32 v18, 119799808, v18
buffer_store_dwordx2 v[24:25], v18, s[8:11], 0 offen
s_mov_b64 exec, s[48:49]
v_cmp_eq_u32 vcc, 1, v14
s_and_saveexec_b64 s[48:49], vcc
s_lshl_b32 s44, s40, 3
v_add_u32 v18, s44, v16
v_mul_u32_u24 v18, 12288, v18
v_add_u32 v19, s43, v15
v_lshl_add_u32 v18, v19, 1, v18
v_add_u32 v18, 113508352, v18
buffer_store_short v24, v18, s[8:11], 0 offen
v_add_u32 v18, 12288, v18
buffer_store_short_d16_hi v24, v18, s[8:11], 0 offen
v_add_u32 v18, 12288, v18
buffer_store_short v25, v18, s[8:11], 0 offen
v_add_u32 v18, 12288, v18
buffer_store_short_d16_hi v25, v18, s[8:11], 0 offen
s_mov_b64 exec, s[48:49]
ch_kernel_k0:
s_mov_b64 exec, s[46:47]
v_add_u32 v10, 256, v0
v_cmp_gt_u32 vcc, 288, v10
s_and_saveexec_b64 s[46:47], vcc
s_cbranch_execz ch_kernel_k1
v_lshlrev_b32 v11, 4, v10
ds_read_b128 v[20:23], v11 offset:10496
ds_read_b128 v[24:27], v11 offset:15104
ds_read_b128 v[28:31], v11 offset:19712
ds_read_b128 v[32:35], v11 offset:24320
s_waitcnt lgkmcnt(0)
v_add_f32 v20, v20, v24
v_add_f32 v28, v28, v32
v_add_f32 v20, v20, v28
v_add_f32 v21, v21, v25
v_add_f32 v29, v29, v33
v_add_f32 v21, v21, v29
v_add_f32 v22, v22, v26
v_add_f32 v30, v30, v34
v_add_f32 v22, v22, v30
v_add_f32 v23, v23, v27
v_add_f32 v31, v31, v35
v_add_f32 v23, v23, v31
v_cvt_pk_bf16_f32 v24, v20, v21
v_cvt_pk_bf16_f32 v25, v22, v23
v_lshrrev_b32 v12, 5, v10
v_and_b32 v13, 31, v10
v_cmp_lt_u32 vcc, 2, v12
v_cndmask_b32 v14, 0, 1, vcc
v_cmp_lt_u32 vcc, 5, v12
v_cndmask_b32 v15, 0, 1, vcc
v_add_u32 v14, v14, v15
v_mul_u32_u24 v15, 3, v14
v_sub_u32 v15, v12, v15
v_lshlrev_b32 v15, 4, v15
v_and_b32 v16, 15, v13
v_add_u32 v15, v15, v16
v_lshrrev_b32 v16, 4, v13
v_lshlrev_b32 v16, 2, v16
v_mul_u32_u24 v17, 896, v14
v_mul_u32_u24 v18, 112, v16
v_add_u32 v17, v17, v18
v_lshl_add_u32 v17, v15, 1, v17
ds_write_b16 v17, v24 offset:29184
ds_write_b16_d16_hi v17, v24 offset:29296
ds_write_b16 v17, v25 offset:29408
ds_write_b16_d16_hi v17, v25 offset:29520
v_lshlrev_b32 v17, 4, v15
v_lshl_add_u32 v17, v16, 1, v17
v_cmp_eq_u32 vcc, 2, v14
s_and_saveexec_b64 s[48:49], vcc
ds_write_b64 v17, v[24:25] offset:34560
v_add_u32 v18, s43, v15
s_mul_i32 s44, s40, 6144
v_add_u32 v18, s44, v18
v_lshl_add_u32 v18, v18, 3, v16
v_lshlrev_b32 v18, 1, v18
v_add_u32 v18, 119799808, v18
buffer_store_dwordx2 v[24:25], v18, s[8:11], 0 offen
s_mov_b64 exec, s[48:49]
v_cmp_eq_u32 vcc, 1, v14
s_and_saveexec_b64 s[48:49], vcc
s_lshl_b32 s44, s40, 3
v_add_u32 v18, s44, v16
v_mul_u32_u24 v18, 12288, v18
v_add_u32 v19, s43, v15
v_lshl_add_u32 v18, v19, 1, v18
v_add_u32 v18, 113508352, v18
buffer_store_short v24, v18, s[8:11], 0 offen
v_add_u32 v18, 12288, v18
buffer_store_short_d16_hi v24, v18, s[8:11], 0 offen
v_add_u32 v18, 12288, v18
buffer_store_short v25, v18, s[8:11], 0 offen
v_add_u32 v18, 12288, v18
buffer_store_short_d16_hi v25, v18, s[8:11], 0 offen
s_mov_b64 exec, s[48:49]
ch_kernel_k1:
s_mov_b64 exec, s[46:47]
s_waitcnt lgkmcnt(0)
s_barrier
v_cmp_gt_u32 vcc, 64, v0
s_cbranch_vccz ch_kernel_w
v_and_b32 v10, 7, v6
v_mul_u32_u24 v10, 112, v10
v_lshl_add_u32 v11, v7, 4, v10
v_lshl_add_u32 v12, v7, 3, v10
ds_read_b128 v[20:23], v11 offset:29184
ds_read_b64 v[24:25], v12 offset:29248
ds_read_b128 v[64:67], v11 offset:30080
ds_read_b64 v[76:77], v12 offset:30144
s_waitcnt lgkmcnt(0) vmcnt(0)
s_mul_i32 s44, s2, 1536
v_lshlrev_b32 v13, 4, v2
v_add_u32 v13, s44, v13
v_add_u32 v13, 162811904, v13
v_mov_b32 v40, 0
v_mov_b32 v41, 0
v_mov_b32 v42, 0
v_mov_b32 v43, 0
s_nop 1
v_mfma_f32_16x16x32_bf16 v[40:43], v[20:23], v[64:67], v[40:43]
v_mfma_f32_16x16x16_bf16 v[40:43], v[24:25], v[76:77], v[40:43]
s_nop 7
v_and_b32 v40, 0xffffffc0, v40
v_or_b32 v40, s40, v40
v_and_b32 v41, 0xffffffc0, v41
v_or_b32 v41, s40, v41
v_and_b32 v42, 0xffffffc0, v42
v_or_b32 v42, s40, v42
v_and_b32 v43, 0xffffffc0, v43
v_or_b32 v43, s40, v43
v_cmp_gt_u32 vcc, 32, v2
s_and_saveexec_b64 s[46:47], vcc
buffer_store_dwordx4 v[40:43], v13, s[8:11], 0 offen offset:0 sc1
s_mov_b64 exec, s[46:47]
v_mov_b32 v40, 0
v_mov_b32 v41, 0
v_mov_b32 v42, 0
v_mov_b32 v43, 0
s_nop 1
v_mfma_f32_16x16x32_bf16 v[40:43], v[20:23], v[68:71], v[40:43]
v_mfma_f32_16x16x16_bf16 v[40:43], v[24:25], v[78:79], v[40:43]
s_nop 7
v_and_b32 v40, 0xffffffc0, v40
v_or_b32 v40, s40, v40
v_and_b32 v41, 0xffffffc0, v41
v_or_b32 v41, s40, v41
v_and_b32 v42, 0xffffffc0, v42
v_or_b32 v42, s40, v42
v_and_b32 v43, 0xffffffc0, v43
v_or_b32 v43, s40, v43
v_cmp_gt_u32 vcc, 32, v2
s_and_saveexec_b64 s[46:47], vcc
buffer_store_dwordx4 v[40:43], v13, s[8:11], 0 offen offset:512 sc1
s_mov_b64 exec, s[46:47]
v_mov_b32 v40, 0
v_mov_b32 v41, 0
v_mov_b32 v42, 0
v_mov_b32 v43, 0
s_nop 1
v_mfma_f32_16x16x32_bf16 v[40:43], v[20:23], v[72:75], v[40:43]
v_mfma_f32_16x16x16_bf16 v[40:43], v[24:25], v[80:81], v[40:43]
s_nop 7
v_and_b32 v40, 0xffffffc0, v40
v_or_b32 v40, s40, v40
v_and_b32 v41, 0xffffffc0, v41
v_or_b32 v41, s40, v41
v_and_b32 v42, 0xffffffc0, v42
v_or_b32 v42, s40, v42
v_and_b32 v43, 0xffffffc0, v43
v_or_b32 v43, s40, v43
v_cmp_gt_u32 vcc, 32, v2
s_and_saveexec_b64 s[46:47], vcc
buffer_store_dwordx4 v[40:43], v13, s[8:11], 0 offen offset:1024 sc1
s_mov_b64 exec, s[46:47]
s_and_b32 s44, s2, 0xfc
s_mul_i32 s44, s44, 1536
v_and_b32 v13, 31, v2
v_lshlrev_b32 v13, 4, v13
v_add_u32 v13, s44, v13
v_add_u32 v13, 162811904, v13
ch_kernel_p2:
buffer_load_dwordx4 v[100:103], v13, s[8:11], 0 offen offset:0 sc1
buffer_load_dwordx4 v[104:107], v13, s[8:11], 0 offen offset:512 sc1
buffer_load_dwordx4 v[108:111], v13, s[8:11], 0 offen offset:1024 sc1
buffer_load_dwordx4 v[112:115], v13, s[8:11], 0 offen offset:1536 sc1
buffer_load_dwordx4 v[116:119], v13, s[8:11], 0 offen offset:2048 sc1
buffer_load_dwordx4 v[120:123], v13, s[8:11], 0 offen offset:2560 sc1
buffer_load_dwordx4 v[124:127], v13, s[8:11], 0 offen offset:3072 sc1
buffer_load_dwordx4 v[128:131], v13, s[8:11], 0 offen offset:3584 sc1
buffer_load_dwordx4 v[132:135], v13, s[8:11], 0 offen offset:4096 sc1
buffer_load_dwordx4 v[136:139], v13, s[8:11], 0 offen offset:4608 sc1
buffer_load_dwordx4 v[140:143], v13, s[8:11], 0 offen offset:5120 sc1
buffer_load_dwordx4 v[144:147], v13, s[8:11], 0 offen offset:5632 sc1
s_waitcnt vmcnt(0)
v_mov_b32 v60, 0
v_xor_b32 v61, s40, v100
v_and_b32 v61, 63, v61
v_or_b32 v60, v60, v61
v_xor_b32 v61, s40, v101
v_and_b32 v61, 63, v61
v_or_b32 v60, v60, v61
v_xor_b32 v61, s40, v102
v_and_b32 v61, 63, v61
v_or_b32 v60, v60, v61
v_xor_b32 v61, s40, v103
v_and_b32 v61, 63, v61
v_or_b32 v60, v60, v61
v_xor_b32 v61, s40, v104
v_and_b32 v61, 63, v61
v_or_b32 v60, v60, v61
v_xor_b32 v61, s40, v105
v_and_b32 v61, 63, v61
v_or_b32 v60, v60, v61
v_xor_b32 v61, s40, v106
v_and_b32 v61, 63, v61
v_or_b32 v60, v60, v61
v_xor_b32 v61, s40, v107
v_and_b32 v61, 63, v61
v_or_b32 v60, v60, v61
v_xor_b32 v61, s40, v108
v_and_b32 v61, 63, v61
v_or_b32 v60, v60, v61
v_xor_b32 v61, s40, v109
v_and_b32 v61, 63, v61
v_or_b32 v60, v60, v61
v_xor_b32 v61, s40, v110
v_and_b32 v61, 63, v61
v_or_b32 v60, v60, v61
v_xor_b32 v61, s40, v111
v_and_b32 v61, 63, v61
v_or_b32 v60, v60, v61
v_xor_b32 v61, s40, v112
v_and_b32 v61, 63, v61
v_or_b32 v60, v60, v61
v_xor_b32 v61, s40, v113
v_and_b32 v61, 63, v61
v_or_b32 v60, v60, v61
v_xor_b32 v61, s40, v114
v_and_b32 v61, 63, v61
v_or_b32 v60, v60, v61
v_xor_b32 v61, s40, v115
v_and_b32 v61, 63, v61
v_or_b32 v60, v60, v61
v_xor_b32 v61, s40, v116
v_and_b32 v61, 63, v61
v_or_b32 v60, v60, v61
v_xor_b32 v61, s40, v117
v_and_b32 v61, 63, v61
v_or_b32 v60, v60, v61
v_xor_b32 v61, s40, v118
v_and_b32 v61, 63, v61
v_or_b32 v60, v60, v61
v_xor_b32 v61, s40, v119
v_and_b32 v61, 63, v61
v_or_b32 v60, v60, v61
v_xor_b32 v61, s40, v120
v_and_b32 v61, 63, v61
v_or_b32 v60, v60, v61
v_xor_b32 v61, s40, v121
v_and_b32 v61, 63, v61
v_or_b32 v60, v60, v61
v_xor_b32 v61, s40, v122
v_and_b32 v61, 63, v61
v_or_b32 v60, v60, v61
v_xor_b32 v61, s40, v123
v_and_b32 v61, 63, v61
v_or_b32 v60, v60, v61
v_xor_b32 v61, s40, v124
v_and_b32 v61, 63, v61
v_or_b32 v60, v60, v61
v_xor_b32 v61, s40, v125
v_and_b32 v61, 63, v61
v_or_b32 v60, v60, v61
v_xor_b32 v61, s40, v126
v_and_b32 v61, 63, v61
v_or_b32 v60, v60, v61
v_xor_b32 v61, s40, v127
v_and_b32 v61, 63, v61
v_or_b32 v60, v60, v61
v_xor_b32 v61, s40, v128
v_and_b32 v61, 63, v61
v_or_b32 v60, v60, v61
v_xor_b32 v61, s40, v129
v_and_b32 v61, 63, v61
v_or_b32 v60, v60, v61
v_xor_b32 v61, s40, v130
v_and_b32 v61, 63, v61
v_or_b32 v60, v60, v61
v_xor_b32 v61, s40, v131
v_and_b32 v61, 63, v61
v_or_b32 v60, v60, v61
v_xor_b32 v61, s40, v132
v_and_b32 v61, 63, v61
v_or_b32 v60, v60, v61
v_xor_b32 v61, s40, v133
v_and_b32 v61, 63, v61
v_or_b32 v60, v60, v61
v_xor_b32 v61, s40, v134
v_and_b32 v61, 63, v61
v_or_b32 v60, v60, v61
v_xor_b32 v61, s40, v135
v_and_b32 v61, 63, v61
v_or_b32 v60, v60, v61
v_xor_b32 v61, s40, v136
v_and_b32 v61, 63, v61
v_or_b32 v60, v60, v61
v_xor_b32 v61, s40, v137
v_and_b32 v61, 63, v61
v_or_b32 v60, v60, v61
v_xor_b32 v61, s40, v138
v_and_b32 v61, 63, v61
v_or_b32 v60, v60, v61
v_xor_b32 v61, s40, v139
v_and_b32 v61, 63, v61
v_or_b32 v60, v60, v61
v_xor_b32 v61, s40, v140
v_and_b32 v61, 63, v61
v_or_b32 v60, v60, v61
v_xor_b32 v61, s40, v141
v_and_b32 v61, 63, v61
v_or_b32 v60, v60, v61
v_xor_b32 v61, s40, v142
v_and_b32 v61, 63, v61
v_or_b32 v60, v60, v61
v_xor_b32 v61, s40, v143
v_and_b32 v61, 63, v61
v_or_b32 v60, v60, v61
v_xor_b32 v61, s40, v144
v_and_b32 v61, 63, v61
v_or_b32 v60, v60, v61
v_xor_b32 v61, s40, v145
v_and_b32 v61, 63, v61
v_or_b32 v60, v60, v61
v_xor_b32 v61, s40, v146
v_and_b32 v61, 63, v61
v_or_b32 v60, v60, v61
v_xor_b32 v61, s40, v147
v_and_b32 v61, 63, v61
v_or_b32 v60, v60, v61
v_cmp_ne_u32 vcc, 0, v60
s_cbranch_vccnz ch_kernel_p2
v_mov_b32 v50, 0xff800000
v_cmp_lt_u32 vcc, 7, v6
v_mov_b32 v56, 0xce6e6b28
v_add_f32 v100, v100, v112
v_add_f32 v124, v124, v136
v_add_f32 v100, v100, v124
v_cvt_pk_bf16_f32 v42, v100, v100
v_lshlrev_b32 v100, 16, v42
v_mul_f32 v100, 0x3d93cd3a, v100
v_cvt_pk_bf16_f32 v42, v100, v100
v_lshlrev_b32 v100, 16, v42
v_cndmask_b32 v100, v100, v56, vcc
v_add_f32 v101, v101, v113
v_add_f32 v125, v125, v137
v_add_f32 v101, v101, v125
v_cvt_pk_bf16_f32 v42, v101, v101
v_lshlrev_b32 v101, 16, v42
v_mul_f32 v101, 0x3d93cd3a, v101
v_cvt_pk_bf16_f32 v42, v101, v101
v_lshlrev_b32 v101, 16, v42
v_cndmask_b32 v101, v101, v56, vcc
v_add_f32 v102, v102, v114
v_add_f32 v126, v126, v138
v_add_f32 v102, v102, v126
v_cvt_pk_bf16_f32 v42, v102, v102
v_lshlrev_b32 v102, 16, v42
v_mul_f32 v102, 0x3d93cd3a, v102
v_cvt_pk_bf16_f32 v42, v102, v102
v_lshlrev_b32 v102, 16, v42
v_cndmask_b32 v102, v102, v56, vcc
v_add_f32 v103, v103, v115
v_add_f32 v127, v127, v139
v_add_f32 v103, v103, v127
v_cvt_pk_bf16_f32 v42, v103, v103
v_lshlrev_b32 v103, 16, v42
v_mul_f32 v103, 0x3d93cd3a, v103
v_cvt_pk_bf16_f32 v42, v103, v103
v_lshlrev_b32 v103, 16, v42
v_cndmask_b32 v103, v103, v56, vcc
v_add_f32 v104, v104, v116
v_add_f32 v128, v128, v140
v_add_f32 v104, v104, v128
v_cvt_pk_bf16_f32 v42, v104, v104
v_lshlrev_b32 v104, 16, v42
v_mul_f32 v104, 0x3d93cd3a, v104
v_cvt_pk_bf16_f32 v42, v104, v104
v_lshlrev_b32 v104, 16, v42
v_add_f32 v105, v105, v117
v_add_f32 v129, v129, v141
v_add_f32 v105, v105, v129
v_cvt_pk_bf16_f32 v42, v105, v105
v_lshlrev_b32 v105, 16, v42
v_mul_f32 v105, 0x3d93cd3a, v105
v_cvt_pk_bf16_f32 v42, v105, v105
v_lshlrev_b32 v105, 16, v42
v_add_f32 v106, v106, v118
v_add_f32 v130, v130, v142
v_add_f32 v106, v106, v130
v_cvt_pk_bf16_f32 v42, v106, v106
v_lshlrev_b32 v106, 16, v42
v_mul_f32 v106, 0x3d93cd3a, v106
v_cvt_pk_bf16_f32 v42, v106, v106
v_lshlrev_b32 v106, 16, v42
v_add_f32 v107, v107, v119
v_add_f32 v131, v131, v143
v_add_f32 v107, v107, v131
v_cvt_pk_bf16_f32 v42, v107, v107
v_lshlrev_b32 v107, 16, v42
v_mul_f32 v107, 0x3d93cd3a, v107
v_cvt_pk_bf16_f32 v42, v107, v107
v_lshlrev_b32 v107, 16, v42
v_add_f32 v108, v108, v120
v_add_f32 v132, v132, v144
v_add_f32 v108, v108, v132
v_cvt_pk_bf16_f32 v42, v108, v108
v_lshlrev_b32 v108, 16, v42
v_mul_f32 v108, 0x3d93cd3a, v108
v_cvt_pk_bf16_f32 v42, v108, v108
v_lshlrev_b32 v108, 16, v42
v_add_f32 v109, v109, v121
v_add_f32 v133, v133, v145
v_add_f32 v109, v109, v133
v_cvt_pk_bf16_f32 v42, v109, v109
v_lshlrev_b32 v109, 16, v42
v_mul_f32 v109, 0x3d93cd3a, v109
v_cvt_pk_bf16_f32 v42, v109, v109
v_lshlrev_b32 v109, 16, v42
v_add_f32 v110, v110, v122
v_add_f32 v134, v134, v146
v_add_f32 v110, v110, v134
v_cvt_pk_bf16_f32 v42, v110, v110
v_lshlrev_b32 v110, 16, v42
v_mul_f32 v110, 0x3d93cd3a, v110
v_cvt_pk_bf16_f32 v42, v110, v110
v_lshlrev_b32 v110, 16, v42
v_add_f32 v111, v111, v123
v_add_f32 v135, v135, v147
v_add_f32 v111, v111, v135
v_cvt_pk_bf16_f32 v42, v111, v111
v_lshlrev_b32 v111, 16, v42
v_mul_f32 v111, 0x3d93cd3a, v111
v_cvt_pk_bf16_f32 v42, v111, v111
v_lshlrev_b32 v111, 16, v42
v_mul_u32_u24 v57, 144, v7
v_lshlrev_b32 v57, 2, v57
v_lshl_add_u32 v57, v6, 1, v57
v_max_f32 v50, v100, v104
v_max_f32 v50, v50, v108
v_xor_b32 v43, 4, v3
ds_bpermute_b32 v42, v43, v50
s_waitcnt lgkmcnt(0)
v_max_f32 v50, v50, v42
v_xor_b32 v43, 8, v3
ds_bpermute_b32 v42, v43, v50
s_waitcnt lgkmcnt(0)
v_max_f32 v50, v50, v42
v_xor_b32 v43, 16, v3
ds_bpermute_b32 v42, v43, v50
s_waitcnt lgkmcnt(0)
v_max_f32 v50, v50, v42
v_xor_b32 v43, 32, v3
ds_bpermute_b32 v42, v43, v50
s_waitcnt lgkmcnt(0)
v_max_f32 v50, v50, v42
v_mov_b32 v51, 0
v_sub_f32 v100, v100, v50
v_mul_f32 v100, 0x3fb8aa3b, v100
v_exp_f32 v100, v100
s_nop 0
v_add_f32 v51, v51, v100
v_sub_f32 v104, v104, v50
v_mul_f32 v104, 0x3fb8aa3b, v104
v_exp_f32 v104, v104
s_nop 0
v_add_f32 v51, v51, v104
v_sub_f32 v108, v108, v50
v_mul_f32 v108, 0x3fb8aa3b, v108
v_exp_f32 v108, v108
s_nop 0
v_add_f32 v51, v51, v108
v_xor_b32 v43, 4, v3
ds_bpermute_b32 v42, v43, v51
s_waitcnt lgkmcnt(0)
v_add_f32 v51, v51, v42
v_xor_b32 v43, 8, v3
ds_bpermute_b32 v42, v43, v51
s_waitcnt lgkmcnt(0)
v_add_f32 v51, v51, v42
v_xor_b32 v43, 16, v3
ds_bpermute_b32 v42, v43, v51
s_waitcnt lgkmcnt(0)
v_add_f32 v51, v51, v42
v_xor_b32 v43, 32, v3
ds_bpermute_b32 v42, v43, v51
s_waitcnt lgkmcnt(0)
v_add_f32 v51, v51, v42
v_rcp_f32 v51, v51
s_nop 0
v_mul_f32 v52, v100, v51
v_cvt_pk_bf16_f32 v52, v52, v52
ds_write_b16 v57, v52 offset:32000
v_mul_f32 v52, v104, v51
v_cvt_pk_bf16_f32 v52, v52, v52
ds_write_b16 v57, v52 offset:32032
v_mul_f32 v52, v108, v51
v_cvt_pk_bf16_f32 v52, v52, v52
ds_write_b16 v57, v52 offset:32064
v_max_f32 v50, v101, v105
v_max_f32 v50, v50, v109
v_xor_b32 v43, 4, v3
ds_bpermute_b32 v42, v43, v50
s_waitcnt lgkmcnt(0)
v_max_f32 v50, v50, v42
v_xor_b32 v43, 8, v3
ds_bpermute_b32 v42, v43, v50
s_waitcnt lgkmcnt(0)
v_max_f32 v50, v50, v42
v_xor_b32 v43, 16, v3
ds_bpermute_b32 v42, v43, v50
s_waitcnt lgkmcnt(0)
v_max_f32 v50, v50, v42
v_xor_b32 v43, 32, v3
ds_bpermute_b32 v42, v43, v50
s_waitcnt lgkmcnt(0)
v_max_f32 v50, v50, v42
v_mov_b32 v51, 0
v_sub_f32 v101, v101, v50
v_mul_f32 v101, 0x3fb8aa3b, v101
v_exp_f32 v101, v101
s_nop 0
v_add_f32 v51, v51, v101
v_sub_f32 v105, v105, v50
v_mul_f32 v105, 0x3fb8aa3b, v105
v_exp_f32 v105, v105
s_nop 0
v_add_f32 v51, v51, v105
v_sub_f32 v109, v109, v50
v_mul_f32 v109, 0x3fb8aa3b, v109
v_exp_f32 v109, v109
s_nop 0
v_add_f32 v51, v51, v109
v_xor_b32 v43, 4, v3
ds_bpermute_b32 v42, v43, v51
s_waitcnt lgkmcnt(0)
v_add_f32 v51, v51, v42
v_xor_b32 v43, 8, v3
ds_bpermute_b32 v42, v43, v51
s_waitcnt lgkmcnt(0)
v_add_f32 v51, v51, v42
v_xor_b32 v43, 16, v3
ds_bpermute_b32 v42, v43, v51
s_waitcnt lgkmcnt(0)
v_add_f32 v51, v51, v42
v_xor_b32 v43, 32, v3
ds_bpermute_b32 v42, v43, v51
s_waitcnt lgkmcnt(0)
v_add_f32 v51, v51, v42
v_rcp_f32 v51, v51
s_nop 0
v_mul_f32 v52, v101, v51
v_cvt_pk_bf16_f32 v52, v52, v52
ds_write_b16 v57, v52 offset:32144
v_mul_f32 v52, v105, v51
v_cvt_pk_bf16_f32 v52, v52, v52
ds_write_b16 v57, v52 offset:32176
v_mul_f32 v52, v109, v51
v_cvt_pk_bf16_f32 v52, v52, v52
ds_write_b16 v57, v52 offset:32208
v_max_f32 v50, v102, v106
v_max_f32 v50, v50, v110
v_xor_b32 v43, 4, v3
ds_bpermute_b32 v42, v43, v50
s_waitcnt lgkmcnt(0)
v_max_f32 v50, v50, v42
v_xor_b32 v43, 8, v3
ds_bpermute_b32 v42, v43, v50
s_waitcnt lgkmcnt(0)
v_max_f32 v50, v50, v42
v_xor_b32 v43, 16, v3
ds_bpermute_b32 v42, v43, v50
s_waitcnt lgkmcnt(0)
v_max_f32 v50, v50, v42
v_xor_b32 v43, 32, v3
ds_bpermute_b32 v42, v43, v50
s_waitcnt lgkmcnt(0)
v_max_f32 v50, v50, v42
v_mov_b32 v51, 0
v_sub_f32 v102, v102, v50
v_mul_f32 v102, 0x3fb8aa3b, v102
v_exp_f32 v102, v102
s_nop 0
v_add_f32 v51, v51, v102
v_sub_f32 v106, v106, v50
v_mul_f32 v106, 0x3fb8aa3b, v106
v_exp_f32 v106, v106
s_nop 0
v_add_f32 v51, v51, v106
v_sub_f32 v110, v110, v50
v_mul_f32 v110, 0x3fb8aa3b, v110
v_exp_f32 v110, v110
s_nop 0
v_add_f32 v51, v51, v110
v_xor_b32 v43, 4, v3
ds_bpermute_b32 v42, v43, v51
s_waitcnt lgkmcnt(0)
v_add_f32 v51, v51, v42
v_xor_b32 v43, 8, v3
ds_bpermute_b32 v42, v43, v51
s_waitcnt lgkmcnt(0)
v_add_f32 v51, v51, v42
v_xor_b32 v43, 16, v3
ds_bpermute_b32 v42, v43, v51
s_waitcnt lgkmcnt(0)
v_add_f32 v51, v51, v42
v_xor_b32 v43, 32, v3
ds_bpermute_b32 v42, v43, v51
s_waitcnt lgkmcnt(0)
v_add_f32 v51, v51, v42
v_rcp_f32 v51, v51
s_nop 0
v_mul_f32 v52, v102, v51
v_cvt_pk_bf16_f32 v52, v52, v52
ds_write_b16 v57, v52 offset:32288
v_mul_f32 v52, v106, v51
v_cvt_pk_bf16_f32 v52, v52, v52
ds_write_b16 v57, v52 offset:32320
v_mul_f32 v52, v110, v51
v_cvt_pk_bf16_f32 v52, v52, v52
ds_write_b16 v57, v52 offset:32352
v_max_f32 v50, v103, v107
v_max_f32 v50, v50, v111
v_xor_b32 v43, 4, v3
ds_bpermute_b32 v42, v43, v50
s_waitcnt lgkmcnt(0)
v_max_f32 v50, v50, v42
v_xor_b32 v43, 8, v3
ds_bpermute_b32 v42, v43, v50
s_waitcnt lgkmcnt(0)
v_max_f32 v50, v50, v42
v_xor_b32 v43, 16, v3
ds_bpermute_b32 v42, v43, v50
s_waitcnt lgkmcnt(0)
v_max_f32 v50, v50, v42
v_xor_b32 v43, 32, v3
ds_bpermute_b32 v42, v43, v50
s_waitcnt lgkmcnt(0)
v_max_f32 v50, v50, v42
v_mov_b32 v51, 0
v_sub_f32 v103, v103, v50
v_mul_f32 v103, 0x3fb8aa3b, v103
v_exp_f32 v103, v103
s_nop 0
v_add_f32 v51, v51, v103
v_sub_f32 v107, v107, v50
v_mul_f32 v107, 0x3fb8aa3b, v107
v_exp_f32 v107, v107
s_nop 0
v_add_f32 v51, v51, v107
v_sub_f32 v111, v111, v50
v_mul_f32 v111, 0x3fb8aa3b, v111
v_exp_f32 v111, v111
s_nop 0
v_add_f32 v51, v51, v111
v_xor_b32 v43, 4, v3
ds_bpermute_b32 v42, v43, v51
s_waitcnt lgkmcnt(0)
v_add_f32 v51, v51, v42
v_xor_b32 v43, 8, v3
ds_bpermute_b32 v42, v43, v51
s_waitcnt lgkmcnt(0)
v_add_f32 v51, v51, v42
v_xor_b32 v43, 16, v3
ds_bpermute_b32 v42, v43, v51
s_waitcnt lgkmcnt(0)
v_add_f32 v51, v51, v42
v_xor_b32 v43, 32, v3
ds_bpermute_b32 v42, v43, v51
s_waitcnt lgkmcnt(0)
v_add_f32 v51, v51, v42
v_rcp_f32 v51, v51
s_nop 0
v_mul_f32 v52, v103, v51
v_cvt_pk_bf16_f32 v52, v52, v52
ds_write_b16 v57, v52 offset:32432
v_mul_f32 v52, v107, v51
v_cvt_pk_bf16_f32 v52, v52, v52
ds_write_b16 v57, v52 offset:32464
v_mul_f32 v52, v111, v51
v_cvt_pk_bf16_f32 v52, v52, v52
ds_write_b16 v57, v52 offset:32496
s_waitcnt lgkmcnt(0)
v_and_b32 v10, 7, v6
v_mul_u32_u24 v10, 144, v10
v_lshl_add_u32 v11, v7, 4, v10
v_lshl_add_u32 v12, v7, 3, v10
ds_read_b128 v[20:23], v11 offset:32000
ds_read_b64 v[24:25], v12 offset:32064
v_cmp_eq_u32 vcc, 0, v7
v_cmp_eq_u32 s[46:47], 1, v7
v_lshlrev_b32 v13, 4, v6
ds_read_b128 v[26:29], v13 offset:34560
s_waitcnt lgkmcnt(0)
v_cndmask_b32 v82, v82, v26, vcc
v_cndmask_b32 v82, v82, 0, s[46:47]
v_cndmask_b32 v83, v83, v27, vcc
v_cndmask_b32 v83, v83, 0, s[46:47]
v_cndmask_b32 v84, v84, v28, vcc
v_cndmask_b32 v84, v84, 0, s[46:47]
v_cndmask_b32 v85, v85, v29, vcc
v_cndmask_b32 v85, v85, 0, s[46:47]
v_mov_b32 v40, 0
v_mov_b32 v41, 0
v_mov_b32 v42, 0
v_mov_b32 v43, 0
s_nop 1
v_mfma_f32_16x16x32_bf16 v[40:43], v[20:23], v[82:85], v[40:43]
v_mfma_f32_16x16x16_bf16 v[40:43], v[24:25], v[94:95], v[40:43]
s_nop 7
v_mul_u32_u24 v13, 448, v7
v_lshl_add_u32 v13, v6, 1, v13
v_cvt_pk_bf16_f32 v44, v40, v41
v_cvt_pk_bf16_f32 v45, v42, v43
ds_write_b16 v13, v44 offset:33280
ds_write_b16_d16_hi v13, v44 offset:33392
ds_write_b16 v13, v45 offset:33504
ds_write_b16_d16_hi v13, v45 offset:33616
v_lshlrev_b32 v13, 4, v6
ds_read_b128 v[26:29], v13 offset:34816
s_waitcnt lgkmcnt(0)
v_cndmask_b32 v86, v86, v26, vcc
v_cndmask_b32 v86, v86, 0, s[46:47]
v_cndmask_b32 v87, v87, v27, vcc
v_cndmask_b32 v87, v87, 0, s[46:47]
v_cndmask_b32 v88, v88, v28, vcc
v_cndmask_b32 v88, v88, 0, s[46:47]
v_cndmask_b32 v89, v89, v29, vcc
v_cndmask_b32 v89, v89, 0, s[46:47]
v_mov_b32 v40, 0
v_mov_b32 v41, 0
v_mov_b32 v42, 0
v_mov_b32 v43, 0
s_nop 1
v_mfma_f32_16x16x32_bf16 v[40:43], v[20:23], v[86:89], v[40:43]
v_mfma_f32_16x16x16_bf16 v[40:43], v[24:25], v[96:97], v[40:43]
s_nop 7
v_mul_u32_u24 v13, 448, v7
v_lshl_add_u32 v13, v6, 1, v13
v_cvt_pk_bf16_f32 v44, v40, v41
v_cvt_pk_bf16_f32 v45, v42, v43
ds_write_b16 v13, v44 offset:33312
ds_write_b16_d16_hi v13, v44 offset:33424
ds_write_b16 v13, v45 offset:33536
ds_write_b16_d16_hi v13, v45 offset:33648
v_lshlrev_b32 v13, 4, v6
ds_read_b128 v[26:29], v13 offset:35072
s_waitcnt lgkmcnt(0)
v_cndmask_b32 v90, v90, v26, vcc
v_cndmask_b32 v90, v90, 0, s[46:47]
v_cndmask_b32 v91, v91, v27, vcc
v_cndmask_b32 v91, v91, 0, s[46:47]
v_cndmask_b32 v92, v92, v28, vcc
v_cndmask_b32 v92, v92, 0, s[46:47]
v_cndmask_b32 v93, v93, v29, vcc
v_cndmask_b32 v93, v93, 0, s[46:47]
v_mov_b32 v40, 0
v_mov_b32 v41, 0
v_mov_b32 v42, 0
v_mov_b32 v43, 0
s_nop 1
v_mfma_f32_16x16x32_bf16 v[40:43], v[20:23], v[90:93], v[40:43]
v_mfma_f32_16x16x16_bf16 v[40:43], v[24:25], v[98:99], v[40:43]
s_nop 7
v_mul_u32_u24 v13, 448, v7
v_lshl_add_u32 v13, v6, 1, v13
v_cvt_pk_bf16_f32 v44, v40, v41
v_cvt_pk_bf16_f32 v45, v42, v43
ds_write_b16 v13, v44 offset:33344
ds_write_b16_d16_hi v13, v44 offset:33456
ds_write_b16 v13, v45 offset:33568
ds_write_b16_d16_hi v13, v45 offset:33680
ch_kernel_w:
s_waitcnt lgkmcnt(0) vmcnt(0)
s_barrier
v_and_b32 v10, 7, v6
v_mul_u32_u24 v10, 112, v10
v_lshl_add_u32 v11, v7, 4, v10
v_lshl_add_u32 v12, v7, 3, v10
ds_read_b128 v[20:23], v11 offset:33280
ds_read_b64 v[24:25], v12 offset:33344
s_waitcnt lgkmcnt(0)
v_mov_b32 v40, 0
v_mov_b32 v41, 0
v_mov_b32 v42, 0
v_mov_b32 v43, 0
s_nop 1
v_mfma_f32_16x16x32_bf16 v[40:43], v[20:23], a[180:183], v[40:43]
v_mfma_f32_16x16x16_bf16 v[40:43], v[24:25], a[184:185], v[40:43]
s_nop 7
v_and_b32 v40, 0xffffffc0, v40
v_or_b32 v40, s40, v40
v_and_b32 v41, 0xffffffc0, v41
v_or_b32 v41, s40, v41
v_and_b32 v42, 0xffffffc0, v42
v_or_b32 v42, s40, v42
v_and_b32 v43, 0xffffffc0, v43
v_or_b32 v43, s40, v43
v_mul_u32_u24 v13, 160, v1
v_add_u32 v13, v13, v6
v_add_u32 v13, 0, v13
s_mov_b32 s44, 0x33333334
v_mul_hi_u32 v14, v13, s44
v_mul_u32_u24 v15, 5, v14
v_sub_u32 v15, v13, v15
v_lshlrev_b32 v14, 7, v14
v_add_u32 v14, s2, v14
v_mul_u32_u24 v14, 160, v14
v_lshl_add_u32 v14, v15, 5, v14
v_lshl_add_u32 v14, v7, 4, v14
v_add_u32 v14, 163008512, v14
v_cmp_gt_u32 vcc, 32, v2
s_and_saveexec_b64 s[46:47], vcc
buffer_store_dwordx4 v[40:43], v14, s[8:11], 0 offen sc1
s_mov_b64 exec, s[46:47]
v_mov_b32 v40, 0
v_mov_b32 v41, 0
v_mov_b32 v42, 0
v_mov_b32 v43, 0
s_nop 1
v_mfma_f32_16x16x32_bf16 v[40:43], v[20:23], a[186:189], v[40:43]
v_mfma_f32_16x16x16_bf16 v[40:43], v[24:25], a[190:191], v[40:43]
s_nop 7
v_and_b32 v40, 0xffffffc0, v40
v_or_b32 v40, s40, v40
v_and_b32 v41, 0xffffffc0, v41
v_or_b32 v41, s40, v41
v_and_b32 v42, 0xffffffc0, v42
v_or_b32 v42, s40, v42
v_and_b32 v43, 0xffffffc0, v43
v_or_b32 v43, s40, v43
v_mul_u32_u24 v13, 160, v1
v_add_u32 v13, v13, v6
v_add_u32 v13, 16, v13
s_mov_b32 s44, 0x33333334
v_mul_hi_u32 v14, v13, s44
v_mul_u32_u24 v15, 5, v14
v_sub_u32 v15, v13, v15
v_lshlrev_b32 v14, 7, v14
v_add_u32 v14, s2, v14
v_mul_u32_u24 v14, 160, v14
v_lshl_add_u32 v14, v15, 5, v14
v_lshl_add_u32 v14, v7, 4, v14
v_add_u32 v14, 163008512, v14
v_cmp_gt_u32 vcc, 32, v2
s_and_saveexec_b64 s[46:47], vcc
buffer_store_dwordx4 v[40:43], v14, s[8:11], 0 offen sc1
s_mov_b64 exec, s[46:47]
v_mov_b32 v40, 0
v_mov_b32 v41, 0
v_mov_b32 v42, 0
v_mov_b32 v43, 0
s_nop 1
v_mfma_f32_16x16x32_bf16 v[40:43], v[20:23], a[192:195], v[40:43]
v_mfma_f32_16x16x16_bf16 v[40:43], v[24:25], a[196:197], v[40:43]
s_nop 7
v_and_b32 v40, 0xffffffc0, v40
v_or_b32 v40, s40, v40
v_and_b32 v41, 0xffffffc0, v41
v_or_b32 v41, s40, v41
v_and_b32 v42, 0xffffffc0, v42
v_or_b32 v42, s40, v42
v_and_b32 v43, 0xffffffc0, v43
v_or_b32 v43, s40, v43
v_mul_u32_u24 v13, 160, v1
v_add_u32 v13, v13, v6
v_add_u32 v13, 32, v13
s_mov_b32 s44, 0x33333334
v_mul_hi_u32 v14, v13, s44
v_mul_u32_u24 v15, 5, v14
v_sub_u32 v15, v13, v15
v_lshlrev_b32 v14, 7, v14
v_add_u32 v14, s2, v14
v_mul_u32_u24 v14, 160, v14
v_lshl_add_u32 v14, v15, 5, v14
v_lshl_add_u32 v14, v7, 4, v14
v_add_u32 v14, 163008512, v14
v_cmp_gt_u32 vcc, 32, v2
s_and_saveexec_b64 s[46:47], vcc
buffer_store_dwordx4 v[40:43], v14, s[8:11], 0 offen sc1
s_mov_b64 exec, s[46:47]
v_mov_b32 v40, 0
v_mov_b32 v41, 0
v_mov_b32 v42, 0
v_mov_b32 v43, 0
s_nop 1
v_mfma_f32_16x16x32_bf16 v[40:43], v[20:23], a[198:201], v[40:43]
v_mfma_f32_16x16x16_bf16 v[40:43], v[24:25], a[202:203], v[40:43]
s_nop 7
v_and_b32 v40, 0xffffffc0, v40
v_or_b32 v40, s40, v40
v_and_b32 v41, 0xffffffc0, v41
v_or_b32 v41, s40, v41
v_and_b32 v42, 0xffffffc0, v42
v_or_b32 v42, s40, v42
v_and_b32 v43, 0xffffffc0, v43
v_or_b32 v43, s40, v43
v_mul_u32_u24 v13, 160, v1
v_add_u32 v13, v13, v6
v_add_u32 v13, 48, v13
s_mov_b32 s44, 0x33333334
v_mul_hi_u32 v14, v13, s44
v_mul_u32_u24 v15, 5, v14
v_sub_u32 v15, v13, v15
v_lshlrev_b32 v14, 7, v14
v_add_u32 v14, s2, v14
v_mul_u32_u24 v14, 160, v14
v_lshl_add_u32 v14, v15, 5, v14
v_lshl_add_u32 v14, v7, 4, v14
v_add_u32 v14, 163008512, v14
v_cmp_gt_u32 vcc, 32, v2
s_and_saveexec_b64 s[46:47], vcc
buffer_store_dwordx4 v[40:43], v14, s[8:11], 0 offen sc1
s_mov_b64 exec, s[46:47]
v_mov_b32 v40, 0
v_mov_b32 v41, 0
v_mov_b32 v42, 0
v_mov_b32 v43, 0
s_nop 1
v_mfma_f32_16x16x32_bf16 v[40:43], v[20:23], a[204:207], v[40:43]
v_mfma_f32_16x16x16_bf16 v[40:43], v[24:25], a[208:209], v[40:43]
s_nop 7
v_and_b32 v40, 0xffffffc0, v40
v_or_b32 v40, s40, v40
v_and_b32 v41, 0xffffffc0, v41
v_or_b32 v41, s40, v41
v_and_b32 v42, 0xffffffc0, v42
v_or_b32 v42, s40, v42
v_and_b32 v43, 0xffffffc0, v43
v_or_b32 v43, s40, v43
v_mul_u32_u24 v13, 160, v1
v_add_u32 v13, v13, v6
v_add_u32 v13, 64, v13
s_mov_b32 s44, 0x33333334
v_mul_hi_u32 v14, v13, s44
v_mul_u32_u24 v15, 5, v14
v_sub_u32 v15, v13, v15
v_lshlrev_b32 v14, 7, v14
v_add_u32 v14, s2, v14
v_mul_u32_u24 v14, 160, v14
v_lshl_add_u32 v14, v15, 5, v14
v_lshl_add_u32 v14, v7, 4, v14
v_add_u32 v14, 163008512, v14
v_cmp_gt_u32 vcc, 32, v2
s_and_saveexec_b64 s[46:47], vcc
buffer_store_dwordx4 v[40:43], v14, s[8:11], 0 offen sc1
s_mov_b64 exec, s[46:47]
v_mov_b32 v40, 0
v_mov_b32 v41, 0
v_mov_b32 v42, 0
v_mov_b32 v43, 0
s_nop 1
v_mfma_f32_16x16x32_bf16 v[40:43], v[20:23], a[210:213], v[40:43]
v_mfma_f32_16x16x16_bf16 v[40:43], v[24:25], a[214:215], v[40:43]
s_nop 7
v_and_b32 v40, 0xffffffc0, v40
v_or_b32 v40, s40, v40
v_and_b32 v41, 0xffffffc0, v41
v_or_b32 v41, s40, v41
v_and_b32 v42, 0xffffffc0, v42
v_or_b32 v42, s40, v42
v_and_b32 v43, 0xffffffc0, v43
v_or_b32 v43, s40, v43
v_mul_u32_u24 v13, 160, v1
v_add_u32 v13, v13, v6
v_add_u32 v13, 80, v13
s_mov_b32 s44, 0x33333334
v_mul_hi_u32 v14, v13, s44
v_mul_u32_u24 v15, 5, v14
v_sub_u32 v15, v13, v15
v_lshlrev_b32 v14, 7, v14
v_add_u32 v14, s2, v14
v_mul_u32_u24 v14, 160, v14
v_lshl_add_u32 v14, v15, 5, v14
v_lshl_add_u32 v14, v7, 4, v14
v_add_u32 v14, 163008512, v14
v_cmp_gt_u32 vcc, 32, v2
s_and_saveexec_b64 s[46:47], vcc
buffer_store_dwordx4 v[40:43], v14, s[8:11], 0 offen sc1
s_mov_b64 exec, s[46:47]
v_mov_b32 v40, 0
v_mov_b32 v41, 0
v_mov_b32 v42, 0
v_mov_b32 v43, 0
s_nop 1
v_mfma_f32_16x16x32_bf16 v[40:43], v[20:23], a[216:219], v[40:43]
v_mfma_f32_16x16x16_bf16 v[40:43], v[24:25], a[220:221], v[40:43]
s_nop 7
v_and_b32 v40, 0xffffffc0, v40
v_or_b32 v40, s40, v40
v_and_b32 v41, 0xffffffc0, v41
v_or_b32 v41, s40, v41
v_and_b32 v42, 0xffffffc0, v42
v_or_b32 v42, s40, v42
v_and_b32 v43, 0xffffffc0, v43
v_or_b32 v43, s40, v43
v_mul_u32_u24 v13, 160, v1
v_add_u32 v13, v13, v6
v_add_u32 v13, 96, v13
s_mov_b32 s44, 0x33333334
v_mul_hi_u32 v14, v13, s44
v_mul_u32_u24 v15, 5, v14
v_sub_u32 v15, v13, v15
v_lshlrev_b32 v14, 7, v14
v_add_u32 v14, s2, v14
v_mul_u32_u24 v14, 160, v14
v_lshl_add_u32 v14, v15, 5, v14
v_lshl_add_u32 v14, v7, 4, v14
v_add_u32 v14, 163008512, v14
v_cmp_gt_u32 vcc, 32, v2
s_and_saveexec_b64 s[46:47], vcc
buffer_store_dwordx4 v[40:43], v14, s[8:11], 0 offen sc1
s_mov_b64 exec, s[46:47]
v_mov_b32 v40, 0
v_mov_b32 v41, 0
v_mov_b32 v42, 0
v_mov_b32 v43, 0
s_nop 1
v_mfma_f32_16x16x32_bf16 v[40:43], v[20:23], a[222:225], v[40:43]
v_mfma_f32_16x16x16_bf16 v[40:43], v[24:25], a[226:227], v[40:43]
s_nop 7
v_and_b32 v40, 0xffffffc0, v40
v_or_b32 v40, s40, v40
v_and_b32 v41, 0xffffffc0, v41
v_or_b32 v41, s40, v41
v_and_b32 v42, 0xffffffc0, v42
v_or_b32 v42, s40, v42
v_and_b32 v43, 0xffffffc0, v43
v_or_b32 v43, s40, v43
v_mul_u32_u24 v13, 160, v1
v_add_u32 v13, v13, v6
v_add_u32 v13, 112, v13
s_mov_b32 s44, 0x33333334
v_mul_hi_u32 v14, v13, s44
v_mul_u32_u24 v15, 5, v14
v_sub_u32 v15, v13, v15
v_lshlrev_b32 v14, 7, v14
v_add_u32 v14, s2, v14
v_mul_u32_u24 v14, 160, v14
v_lshl_add_u32 v14, v15, 5, v14
v_lshl_add_u32 v14, v7, 4, v14
v_add_u32 v14, 163008512, v14
v_cmp_gt_u32 vcc, 32, v2
s_and_saveexec_b64 s[46:47], vcc
buffer_store_dwordx4 v[40:43], v14, s[8:11], 0 offen sc1
s_mov_b64 exec, s[46:47]
v_mov_b32 v40, 0
v_mov_b32 v41, 0
v_mov_b32 v42, 0
v_mov_b32 v43, 0
s_nop 1
v_mfma_f32_16x16x32_bf16 v[40:43], v[20:23], a[228:231], v[40:43]
v_mfma_f32_16x16x16_bf16 v[40:43], v[24:25], a[232:233], v[40:43]
s_nop 7
v_and_b32 v40, 0xffffffc0, v40
v_or_b32 v40, s40, v40
v_and_b32 v41, 0xffffffc0, v41
v_or_b32 v41, s40, v41
v_and_b32 v42, 0xffffffc0, v42
v_or_b32 v42, s40, v42
v_and_b32 v43, 0xffffffc0, v43
v_or_b32 v43, s40, v43
v_mul_u32_u24 v13, 160, v1
v_add_u32 v13, v13, v6
v_add_u32 v13, 128, v13
s_mov_b32 s44, 0x33333334
v_mul_hi_u32 v14, v13, s44
v_mul_u32_u24 v15, 5, v14
v_sub_u32 v15, v13, v15
v_lshlrev_b32 v14, 7, v14
v_add_u32 v14, s2, v14
v_mul_u32_u24 v14, 160, v14
v_lshl_add_u32 v14, v15, 5, v14
v_lshl_add_u32 v14, v7, 4, v14
v_add_u32 v14, 163008512, v14
v_cmp_gt_u32 vcc, 32, v2
s_and_saveexec_b64 s[46:47], vcc
buffer_store_dwordx4 v[40:43], v14, s[8:11], 0 offen sc1
s_mov_b64 exec, s[46:47]
v_mov_b32 v40, 0
v_mov_b32 v41, 0
v_mov_b32 v42, 0
v_mov_b32 v43, 0
s_nop 1
v_mfma_f32_16x16x32_bf16 v[40:43], v[20:23], a[234:237], v[40:43]
v_mfma_f32_16x16x16_bf16 v[40:43], v[24:25], a[238:239], v[40:43]
s_nop 7
v_and_b32 v40, 0xffffffc0, v40
v_or_b32 v40, s40, v40
v_and_b32 v41, 0xffffffc0, v41
v_or_b32 v41, s40, v41
v_and_b32 v42, 0xffffffc0, v42
v_or_b32 v42, s40, v42
v_and_b32 v43, 0xffffffc0, v43
v_or_b32 v43, s40, v43
v_mul_u32_u24 v13, 160, v1
v_add_u32 v13, v13, v6
v_add_u32 v13, 144, v13
s_mov_b32 s44, 0x33333334
v_mul_hi_u32 v14, v13, s44
v_mul_u32_u24 v15, 5, v14
v_sub_u32 v15, v13, v15
v_lshlrev_b32 v14, 7, v14
v_add_u32 v14, s2, v14
v_mul_u32_u24 v14, 160, v14
v_lshl_add_u32 v14, v15, 5, v14
v_lshl_add_u32 v14, v7, 4, v14
v_add_u32 v14, 163008512, v14
v_cmp_gt_u32 vcc, 32, v2
s_and_saveexec_b64 s[46:47], vcc
buffer_store_dwordx4 v[40:43], v14, s[8:11], 0 offen sc1
s_mov_b64 exec, s[46:47]
v_cmp_gt_u32 vcc, 40, v0
s_and_saveexec_b64 s[46:47], vcc
v_lshlrev_b32 v10, 2, v0
v_mov_b32 v11, 0
ds_write_b32 v10, v11 offset:34304
s_mov_b64 exec, s[46:47]
s_waitcnt lgkmcnt(0)
s_barrier
s_mul_i32 s44, s2, 20480
v_mul_u32_u24 v13, 80, v0
v_add_u32 v13, s44, v13
v_add_u32 v13, 163008512, v13
ch_kernel_p3:
buffer_load_dwordx4 v[20:23], v13, s[8:11], 0 offen offset:0 sc1
buffer_load_dwordx4 v[24:27], v13, s[8:11], 0 offen offset:16 sc1
buffer_load_dwordx4 v[28:31], v13, s[8:11], 0 offen offset:32 sc1
buffer_load_dwordx4 v[32:35], v13, s[8:11], 0 offen offset:48 sc1
buffer_load_dwordx4 v[36:39], v13, s[8:11], 0 offen offset:64 sc1
s_waitcnt vmcnt(0)
v_mov_b32 v60, 0
v_xor_b32 v61, s40, v20
v_and_b32 v61, 63, v61
v_or_b32 v60, v60, v61
v_xor_b32 v61, s40, v21
v_and_b32 v61, 63, v61
v_or_b32 v60, v60, v61
v_xor_b32 v61, s40, v22
v_and_b32 v61, 63, v61
v_or_b32 v60, v60, v61
v_xor_b32 v61, s40, v23
v_and_b32 v61, 63, v61
v_or_b32 v60, v60, v61
v_xor_b32 v61, s40, v24
v_and_b32 v61, 63, v61
v_or_b32 v60, v60, v61
v_xor_b32 v61, s40, v25
v_and_b32 v61, 63, v61
v_or_b32 v60, v60, v61
v_xor_b32 v61, s40, v26
v_and_b32 v61, 63, v61
v_or_b32 v60, v60, v61
v_xor_b32 v61, s40, v27
v_and_b32 v61, 63, v61
v_or_b32 v60, v60, v61
v_xor_b32 v61, s40, v28
v_and_b32 v61, 63, v61
v_or_b32 v60, v60, v61
v_xor_b32 v61, s40, v29
v_and_b32 v61, 63, v61
v_or_b32 v60, v60, v61
v_xor_b32 v61, s40, v30
v_and_b32 v61, 63, v61
v_or_b32 v60, v60, v61
v_xor_b32 v61, s40, v31
v_and_b32 v61, 63, v61
v_or_b32 v60, v60, v61
v_xor_b32 v61, s40, v32
v_and_b32 v61, 63, v61
v_or_b32 v60, v60, v61
v_xor_b32 v61, s40, v33
v_and_b32 v61, 63, v61
v_or_b32 v60, v60, v61
v_xor_b32 v61, s40, v34
v_and_b32 v61, 63, v61
v_or_b32 v60, v60, v61
v_xor_b32 v61, s40, v35
v_and_b32 v61, 63, v61
v_or_b32 v60, v60, v61
v_xor_b32 v61, s40, v36
v_and_b32 v61, 63, v61
v_or_b32 v60, v60, v61
v_xor_b32 v61, s40, v37
v_and_b32 v61, 63, v61
v_or_b32 v60, v60, v61
v_xor_b32 v61, s40, v38
v_and_b32 v61, 63, v61
v_or_b32 v60, v60, v61
v_xor_b32 v61, s40, v39
v_and_b32 v61, 63, v61
v_or_b32 v60, v60, v61
v_cmp_ne_u32 vcc, 0, v60
s_cbranch_vccnz ch_kernel_p3
v_and_b32 v10, 1, v0
v_mul_u32_u24 v10, 80, v10
ds_add_f32 v10, v20 offset:34304
ds_add_f32 v10, v21 offset:34308
ds_add_f32 v10, v22 offset:34312
ds_add_f32 v10, v23 offset:34316
ds_add_f32 v10, v24 offset:34320
ds_add_f32 v10, v25 offset:34324
ds_add_f32 v10, v26 offset:34328
ds_add_f32 v10, v27 offset:34332
ds_add_f32 v10, v28 offset:34336
ds_add_f32 v10, v29 offset:34340
ds_add_f32 v10, v30 offset:34344
ds_add_f32 v10, v31 offset:34348
ds_add_f32 v10, v32 offset:34352
ds_add_f32 v10, v33 offset:34356
ds_add_f32 v10, v34 offset:34360
ds_add_f32 v10, v35 offset:34364
ds_add_f32 v10, v36 offset:34368
ds_add_f32 v10, v37 offset:34372
ds_add_f32 v10, v38 offset:34376
ds_add_f32 v10, v39 offset:34380
s_waitcnt lgkmcnt(0)
s_barrier
v_cmp_gt_u32 vcc, 40, v0
s_and_saveexec_b64 s[46:47], vcc
v_lshlrev_b32 v10, 2, v0
ds_read_b32 v11, v10 offset:34304
s_waitcnt lgkmcnt(0)
v_cvt_pk_bf16_f32 v11, v11, v11
v_lshlrev_b32 v11, 16, v11
v_or_b32 v11, s40, v11
s_mul_i32 s44, s2, 160
v_add_u32 v10, s44, v10
v_add_u32 v10, 162791424, v10
buffer_store_dword v11, v10, s[8:11], 0 offen sc1
s_mov_b64 exec, s[46:47]
s_add_u32 s40, s40, 1
s_cmp_lt_u32 s40, 64
s_cbranch_scc1 ch_kernel_s
ch_kernel_e:
s_endpgm
.p2align 8
at_kernel:
s_cmp_ge_u32 s2, 512
s_cbranch_scc1 at_kernel_e
s_load_dwordx2 s[90:91], s[0:1], 112
s_waitcnt lgkmcnt(0)
s_add_u32 s8, s90, 0
s_addc_u32 s9, s91, 0
s_mov_b32 s10, 268435200
s_mov_b32 s11, 0x00020000
v_lshrrev_b32 v1, 6, v0
v_and_b32 v2, 63, v0
v_lshlrev_b32 v3, 2, v2
s_lshl_b32 s3, s2, 2
v_add_u32 v1, s3, v1
v_lshrrev_b32 v4, 5, v1
v_and_b32 v5, 31, v1
v_and_b32 v6, 15, v2
v_lshrrev_b32 v7, 4, v2
v_mul_u32_u24 v8, 384, v5
v_lshl_add_u32 v8, v7, 4, v8
v_lshl_add_u32 v10, v4, 5, v6
v_add_u32 v10, 0, v10
v_mul_u32_u24 v10, 12288, v10
v_add_u32 v10, v10, v8
v_add_u32 v12, 38010880, v10
v_lshl_add_u32 v10, v4, 5, v6
v_add_u32 v10, 16, v10
v_mul_u32_u24 v10, 12288, v10
v_add_u32 v10, v10, v8
v_add_u32 v13, 38010880, v10
v_add_u32 v10, 0, v6
v_lshl_add_u32 v11, v4, 5, v10
v_add_u32 v11, -8, v11
v_min_u32 v11, 2047, v11
v_mul_u32_u24 v11, 12288, v11
v_add_u32 v11, 63176704, v11
v_lshl_add_u32 v9, v4, 3, v10
v_mul_u32_u24 v9, 12288, v9
v_add_u32 v9, 113508352, v9
v_cmp_gt_u32 vcc, 8, v10
s_nop 1
v_cndmask_b32 v11, v11, v9, vcc
v_add_u32 v14, v11, v8
v_add_u32 v10, 16, v6
v_lshl_add_u32 v11, v4, 5, v10
v_add_u32 v11, -8, v11
v_min_u32 v11, 2047, v11
v_mul_u32_u24 v11, 12288, v11
v_add_u32 v11, 63176704, v11
v_lshl_add_u32 v9, v4, 3, v10
v_mul_u32_u24 v9, 12288, v9
v_add_u32 v9, 113508352, v9
v_cmp_gt_u32 vcc, 8, v10
s_nop 1
v_cndmask_b32 v11, v11, v9, vcc
v_add_u32 v15, v11, v8
v_add_u32 v10, 32, v6
v_lshl_add_u32 v11, v4, 5, v10
v_add_u32 v11, -8, v11
v_min_u32 v11, 2047, v11
v_mul_u32_u24 v11, 12288, v11
v_add_u32 v11, 63176704, v11
v_lshl_add_u32 v9, v4, 3, v10
v_mul_u32_u24 v9, 12288, v9
v_add_u32 v9, 113508352, v9
v_cmp_gt_u32 vcc, 8, v10
s_nop 1
v_cndmask_b32 v11, v11, v9, vcc
v_add_u32 v16, v11, v8
v_mov_b32 v64, 0
v_mov_b32 v65, 0
v_mov_b32 v66, 0
v_mov_b32 v67, 0
v_mov_b32 v68, 0
v_mov_b32 v69, 0
v_mov_b32 v70, 0
v_mov_b32 v71, 0
v_mov_b32 v72, 0
v_mov_b32 v73, 0
v_mov_b32 v74, 0
v_mov_b32 v75, 0
v_mov_b32 v76, 0
v_mov_b32 v77, 0
v_mov_b32 v78, 0
v_mov_b32 v79, 0
v_mov_b32 v80, 0
v_mov_b32 v81, 0
v_mov_b32 v82, 0
v_mov_b32 v83, 0
v_mov_b32 v84, 0
v_mov_b32 v85, 0
v_mov_b32 v86, 0
v_mov_b32 v87, 0
buffer_load_dwordx4 v[20:23], v12, s[8:11], 0 offen offset:0
buffer_load_dwordx4 v[24:27], v13, s[8:11], 0 offen offset:0
buffer_load_dwordx4 v[28:31], v14, s[8:11], 0 offen offset:0
buffer_load_dwordx4 v[32:35], v15, s[8:11], 0 offen offset:0
buffer_load_dwordx4 v[36:39], v16, s[8:11], 0 offen offset:0
s_waitcnt vmcnt(0)
v_mfma_f32_16x16x32_bf16 v[64:67], v[28:31], v[20:23], v[64:67]
v_mfma_f32_16x16x32_bf16 v[68:71], v[28:31], v[24:27], v[68:71]
v_mfma_f32_16x16x32_bf16 v[72:75], v[32:35], v[20:23], v[72:75]
v_mfma_f32_16x16x32_bf16 v[76:79], v[32:35], v[24:27], v[76:79]
v_mfma_f32_16x16x32_bf16 v[80:83], v[36:39], v[20:23], v[80:83]
v_mfma_f32_16x16x32_bf16 v[84:87], v[36:39], v[24:27], v[84:87]
buffer_load_dwordx4 v[20:23], v12, s[8:11], 0 offen offset:64
buffer_load_dwordx4 v[24:27], v13, s[8:11], 0 offen offset:64
buffer_load_dwordx4 v[28:31], v14, s[8:11], 0 offen offset:64
buffer_load_dwordx4 v[32:35], v15, s[8:11], 0 offen offset:64
buffer_load_dwordx4 v[36:39], v16, s[8:11], 0 offen offset:64
s_waitcnt vmcnt(0)
v_mfma_f32_16x16x32_bf16 v[64:67], v[28:31], v[20:23], v[64:67]
v_mfma_f32_16x16x32_bf16 v[68:71], v[28:31], v[24:27], v[68:71]
v_mfma_f32_16x16x32_bf16 v[72:75], v[32:35], v[20:23], v[72:75]
v_mfma_f32_16x16x32_bf16 v[76:79], v[32:35], v[24:27], v[76:79]
v_mfma_f32_16x16x32_bf16 v[80:83], v[36:39], v[20:23], v[80:83]
v_mfma_f32_16x16x32_bf16 v[84:87], v[36:39], v[24:27], v[84:87]
buffer_load_dwordx4 v[20:23], v12, s[8:11], 0 offen offset:128
buffer_load_dwordx4 v[24:27], v13, s[8:11], 0 offen offset:128
buffer_load_dwordx4 v[28:31], v14, s[8:11], 0 offen offset:128
buffer_load_dwordx4 v[32:35], v15, s[8:11], 0 offen offset:128
buffer_load_dwordx4 v[36:39], v16, s[8:11], 0 offen offset:128
s_waitcnt vmcnt(0)
v_mfma_f32_16x16x32_bf16 v[64:67], v[28:31], v[20:23], v[64:67]
v_mfma_f32_16x16x32_bf16 v[68:71], v[28:31], v[24:27], v[68:71]
v_mfma_f32_16x16x32_bf16 v[72:75], v[32:35], v[20:23], v[72:75]
v_mfma_f32_16x16x32_bf16 v[76:79], v[32:35], v[24:27], v[76:79]
v_mfma_f32_16x16x32_bf16 v[80:83], v[36:39], v[20:23], v[80:83]
v_mfma_f32_16x16x32_bf16 v[84:87], v[36:39], v[24:27], v[84:87]
buffer_load_dwordx4 v[20:23], v12, s[8:11], 0 offen offset:192
buffer_load_dwordx4 v[24:27], v13, s[8:11], 0 offen offset:192
buffer_load_dwordx4 v[28:31], v14, s[8:11], 0 offen offset:192
buffer_load_dwordx4 v[32:35], v15, s[8:11], 0 offen offset:192
buffer_load_dwordx4 v[36:39], v16, s[8:11], 0 offen offset:192
s_waitcnt vmcnt(0)
v_mfma_f32_16x16x32_bf16 v[64:67], v[28:31], v[20:23], v[64:67]
v_mfma_f32_16x16x32_bf16 v[68:71], v[28:31], v[24:27], v[68:71]
v_mfma_f32_16x16x32_bf16 v[72:75], v[32:35], v[20:23], v[72:75]
v_mfma_f32_16x16x32_bf16 v[76:79], v[32:35], v[24:27], v[76:79]
v_mfma_f32_16x16x32_bf16 v[80:83], v[36:39], v[20:23], v[80:83]
v_mfma_f32_16x16x32_bf16 v[84:87], v[36:39], v[24:27], v[84:87]
buffer_load_dwordx4 v[20:23], v12, s[8:11], 0 offen offset:256
buffer_load_dwordx4 v[24:27], v13, s[8:11], 0 offen offset:256
buffer_load_dwordx4 v[28:31], v14, s[8:11], 0 offen offset:256
buffer_load_dwordx4 v[32:35], v15, s[8:11], 0 offen offset:256
buffer_load_dwordx4 v[36:39], v16, s[8:11], 0 offen offset:256
s_waitcnt vmcnt(0)
v_mfma_f32_16x16x32_bf16 v[64:67], v[28:31], v[20:23], v[64:67]
v_mfma_f32_16x16x32_bf16 v[68:71], v[28:31], v[24:27], v[68:71]
v_mfma_f32_16x16x32_bf16 v[72:75], v[32:35], v[20:23], v[72:75]
v_mfma_f32_16x16x32_bf16 v[76:79], v[32:35], v[24:27], v[76:79]
v_mfma_f32_16x16x32_bf16 v[80:83], v[36:39], v[20:23], v[80:83]
v_mfma_f32_16x16x32_bf16 v[84:87], v[36:39], v[24:27], v[84:87]
buffer_load_dwordx4 v[20:23], v12, s[8:11], 0 offen offset:320
buffer_load_dwordx4 v[24:27], v13, s[8:11], 0 offen offset:320
buffer_load_dwordx4 v[28:31], v14, s[8:11], 0 offen offset:320
buffer_load_dwordx4 v[32:35], v15, s[8:11], 0 offen offset:320
buffer_load_dwordx4 v[36:39], v16, s[8:11], 0 offen offset:320
s_waitcnt vmcnt(0)
v_mfma_f32_16x16x32_bf16 v[64:67], v[28:31], v[20:23], v[64:67]
v_mfma_f32_16x16x32_bf16 v[68:71], v[28:31], v[24:27], v[68:71]
v_mfma_f32_16x16x32_bf16 v[72:75], v[32:35], v[20:23], v[72:75]
v_mfma_f32_16x16x32_bf16 v[76:79], v[32:35], v[24:27], v[76:79]
v_mfma_f32_16x16x32_bf16 v[80:83], v[36:39], v[20:23], v[80:83]
v_mfma_f32_16x16x32_bf16 v[84:87], v[36:39], v[24:27], v[84:87]
s_nop 7
v_mov_b32 v40, 0xff800000
v_cvt_pk_bf16_f32 v42, v64, v64
v_lshlrev_b32 v64, 16, v42
v_mul_f32 v64, 0x3d93cd3a, v64
v_cvt_pk_bf16_f32 v42, v64, v64
v_lshlrev_b32 v64, 16, v42
v_lshl_add_u32 v43, v7, 2, 0
v_add_u32 v44, 8, v6
v_cmp_gt_u32 vcc, v43, v44
v_mov_b32 v45, 0xce6e6b28
v_cndmask_b32 v64, v64, v45, vcc
v_max_f32 v40, v40, v64
v_cvt_pk_bf16_f32 v42, v65, v65
v_lshlrev_b32 v65, 16, v42
v_mul_f32 v65, 0x3d93cd3a, v65
v_cvt_pk_bf16_f32 v42, v65, v65
v_lshlrev_b32 v65, 16, v42
v_lshl_add_u32 v43, v7, 2, 1
v_add_u32 v44, 8, v6
v_cmp_gt_u32 vcc, v43, v44
v_mov_b32 v45, 0xce6e6b28
v_cndmask_b32 v65, v65, v45, vcc
v_max_f32 v40, v40, v65
v_cvt_pk_bf16_f32 v42, v66, v66
v_lshlrev_b32 v66, 16, v42
v_mul_f32 v66, 0x3d93cd3a, v66
v_cvt_pk_bf16_f32 v42, v66, v66
v_lshlrev_b32 v66, 16, v42
v_lshl_add_u32 v43, v7, 2, 2
v_add_u32 v44, 8, v6
v_cmp_gt_u32 vcc, v43, v44
v_mov_b32 v45, 0xce6e6b28
v_cndmask_b32 v66, v66, v45, vcc
v_max_f32 v40, v40, v66
v_cvt_pk_bf16_f32 v42, v67, v67
v_lshlrev_b32 v67, 16, v42
v_mul_f32 v67, 0x3d93cd3a, v67
v_cvt_pk_bf16_f32 v42, v67, v67
v_lshlrev_b32 v67, 16, v42
v_lshl_add_u32 v43, v7, 2, 3
v_add_u32 v44, 8, v6
v_cmp_gt_u32 vcc, v43, v44
v_mov_b32 v45, 0xce6e6b28
v_cndmask_b32 v67, v67, v45, vcc
v_max_f32 v40, v40, v67
v_cvt_pk_bf16_f32 v42, v72, v72
v_lshlrev_b32 v72, 16, v42
v_mul_f32 v72, 0x3d93cd3a, v72
v_cvt_pk_bf16_f32 v42, v72, v72
v_lshlrev_b32 v72, 16, v42
v_lshl_add_u32 v43, v7, 2, 16
v_add_u32 v44, 8, v6
v_cmp_gt_u32 vcc, v43, v44
v_mov_b32 v45, 0xce6e6b28
v_cndmask_b32 v72, v72, v45, vcc
v_max_f32 v40, v40, v72
v_cvt_pk_bf16_f32 v42, v73, v73
v_lshlrev_b32 v73, 16, v42
v_mul_f32 v73, 0x3d93cd3a, v73
v_cvt_pk_bf16_f32 v42, v73, v73
v_lshlrev_b32 v73, 16, v42
v_lshl_add_u32 v43, v7, 2, 17
v_add_u32 v44, 8, v6
v_cmp_gt_u32 vcc, v43, v44
v_mov_b32 v45, 0xce6e6b28
v_cndmask_b32 v73, v73, v45, vcc
v_max_f32 v40, v40, v73
v_cvt_pk_bf16_f32 v42, v74, v74
v_lshlrev_b32 v74, 16, v42
v_mul_f32 v74, 0x3d93cd3a, v74
v_cvt_pk_bf16_f32 v42, v74, v74
v_lshlrev_b32 v74, 16, v42
v_lshl_add_u32 v43, v7, 2, 18
v_add_u32 v44, 8, v6
v_cmp_gt_u32 vcc, v43, v44
v_mov_b32 v45, 0xce6e6b28
v_cndmask_b32 v74, v74, v45, vcc
v_max_f32 v40, v40, v74
v_cvt_pk_bf16_f32 v42, v75, v75
v_lshlrev_b32 v75, 16, v42
v_mul_f32 v75, 0x3d93cd3a, v75
v_cvt_pk_bf16_f32 v42, v75, v75
v_lshlrev_b32 v75, 16, v42
v_lshl_add_u32 v43, v7, 2, 19
v_add_u32 v44, 8, v6
v_cmp_gt_u32 vcc, v43, v44
v_mov_b32 v45, 0xce6e6b28
v_cndmask_b32 v75, v75, v45, vcc
v_max_f32 v40, v40, v75
v_cvt_pk_bf16_f32 v42, v80, v80
v_lshlrev_b32 v80, 16, v42
v_mul_f32 v80, 0x3d93cd3a, v80
v_cvt_pk_bf16_f32 v42, v80, v80
v_lshlrev_b32 v80, 16, v42
v_lshl_add_u32 v43, v7, 2, 32
v_add_u32 v44, 8, v6
v_cmp_gt_u32 vcc, v43, v44
v_mov_b32 v45, 0xce6e6b28
v_cndmask_b32 v80, v80, v45, vcc
v_max_f32 v40, v40, v80
v_cvt_pk_bf16_f32 v42, v81, v81
v_lshlrev_b32 v81, 16, v42
v_mul_f32 v81, 0x3d93cd3a, v81
v_cvt_pk_bf16_f32 v42, v81, v81
v_lshlrev_b32 v81, 16, v42
v_lshl_add_u32 v43, v7, 2, 33
v_add_u32 v44, 8, v6
v_cmp_gt_u32 vcc, v43, v44
v_mov_b32 v45, 0xce6e6b28
v_cndmask_b32 v81, v81, v45, vcc
v_max_f32 v40, v40, v81
v_cvt_pk_bf16_f32 v42, v82, v82
v_lshlrev_b32 v82, 16, v42
v_mul_f32 v82, 0x3d93cd3a, v82
v_cvt_pk_bf16_f32 v42, v82, v82
v_lshlrev_b32 v82, 16, v42
v_lshl_add_u32 v43, v7, 2, 34
v_add_u32 v44, 8, v6
v_cmp_gt_u32 vcc, v43, v44
v_mov_b32 v45, 0xce6e6b28
v_cndmask_b32 v82, v82, v45, vcc
v_max_f32 v40, v40, v82
v_cvt_pk_bf16_f32 v42, v83, v83
v_lshlrev_b32 v83, 16, v42
v_mul_f32 v83, 0x3d93cd3a, v83
v_cvt_pk_bf16_f32 v42, v83, v83
v_lshlrev_b32 v83, 16, v42
v_lshl_add_u32 v43, v7, 2, 35
v_add_u32 v44, 8, v6
v_cmp_gt_u32 vcc, v43, v44
v_mov_b32 v45, 0xce6e6b28
v_cndmask_b32 v83, v83, v45, vcc
v_max_f32 v40, v40, v83
v_xor_b32 v43, 64, v3
ds_bpermute_b32 v42, v43, v40
s_waitcnt lgkmcnt(0)
v_max_f32 v40, v40, v42
v_xor_b32 v43, 128, v3
ds_bpermute_b32 v42, v43, v40
s_waitcnt lgkmcnt(0)
v_max_f32 v40, v40, v42
v_mov_b32 v46, 0
v_sub_f32 v64, v64, v40
v_mul_f32 v64, 0x3fb8aa3b, v64
v_exp_f32 v64, v64
s_nop 0
v_add_f32 v46, v46, v64
v_sub_f32 v65, v65, v40
v_mul_f32 v65, 0x3fb8aa3b, v65
v_exp_f32 v65, v65
s_nop 0
v_add_f32 v46, v46, v65
v_sub_f32 v66, v66, v40
v_mul_f32 v66, 0x3fb8aa3b, v66
v_exp_f32 v66, v66
s_nop 0
v_add_f32 v46, v46, v66
v_sub_f32 v67, v67, v40
v_mul_f32 v67, 0x3fb8aa3b, v67
v_exp_f32 v67, v67
s_nop 0
v_add_f32 v46, v46, v67
v_sub_f32 v72, v72, v40
v_mul_f32 v72, 0x3fb8aa3b, v72
v_exp_f32 v72, v72
s_nop 0
v_add_f32 v46, v46, v72
v_sub_f32 v73, v73, v40
v_mul_f32 v73, 0x3fb8aa3b, v73
v_exp_f32 v73, v73
s_nop 0
v_add_f32 v46, v46, v73
v_sub_f32 v74, v74, v40
v_mul_f32 v74, 0x3fb8aa3b, v74
v_exp_f32 v74, v74
s_nop 0
v_add_f32 v46, v46, v74
v_sub_f32 v75, v75, v40
v_mul_f32 v75, 0x3fb8aa3b, v75
v_exp_f32 v75, v75
s_nop 0
v_add_f32 v46, v46, v75
v_sub_f32 v80, v80, v40
v_mul_f32 v80, 0x3fb8aa3b, v80
v_exp_f32 v80, v80
s_nop 0
v_add_f32 v46, v46, v80
v_sub_f32 v81, v81, v40
v_mul_f32 v81, 0x3fb8aa3b, v81
v_exp_f32 v81, v81
s_nop 0
v_add_f32 v46, v46, v81
v_sub_f32 v82, v82, v40
v_mul_f32 v82, 0x3fb8aa3b, v82
v_exp_f32 v82, v82
s_nop 0
v_add_f32 v46, v46, v82
v_sub_f32 v83, v83, v40
v_mul_f32 v83, 0x3fb8aa3b, v83
v_exp_f32 v83, v83
s_nop 0
v_add_f32 v46, v46, v83
v_xor_b32 v43, 64, v3
ds_bpermute_b32 v42, v43, v46
s_waitcnt lgkmcnt(0)
v_add_f32 v46, v46, v42
v_xor_b32 v43, 128, v3
ds_bpermute_b32 v42, v43, v46
s_waitcnt lgkmcnt(0)
v_add_f32 v46, v46, v42
v_rcp_f32 v46, v46
s_nop 0
v_mul_f32 v64, v64, v46
v_mul_f32 v65, v65, v46
v_mul_f32 v66, v66, v46
v_mul_f32 v67, v67, v46
v_cvt_pk_bf16_f32 v90, v64, v65
v_cvt_pk_bf16_f32 v91, v66, v67
v_mul_f32 v72, v72, v46
v_mul_f32 v73, v73, v46
v_mul_f32 v74, v74, v46
v_mul_f32 v75, v75, v46
v_cvt_pk_bf16_f32 v94, v72, v73
v_cvt_pk_bf16_f32 v95, v74, v75
v_mul_f32 v80, v80, v46
v_mul_f32 v81, v81, v46
v_mul_f32 v82, v82, v46
v_mul_f32 v83, v83, v46
v_cvt_pk_bf16_f32 v98, v80, v81
v_cvt_pk_bf16_f32 v99, v82, v83
v_mov_b32 v41, 0xff800000
v_cvt_pk_bf16_f32 v42, v68, v68
v_lshlrev_b32 v68, 16, v42
v_mul_f32 v68, 0x3d93cd3a, v68
v_cvt_pk_bf16_f32 v42, v68, v68
v_lshlrev_b32 v68, 16, v42
v_lshl_add_u32 v43, v7, 2, 0
v_add_u32 v44, 24, v6
v_cmp_gt_u32 vcc, v43, v44
v_mov_b32 v45, 0xce6e6b28
v_cndmask_b32 v68, v68, v45, vcc
v_max_f32 v41, v41, v68
v_cvt_pk_bf16_f32 v42, v69, v69
v_lshlrev_b32 v69, 16, v42
v_mul_f32 v69, 0x3d93cd3a, v69
v_cvt_pk_bf16_f32 v42, v69, v69
v_lshlrev_b32 v69, 16, v42
v_lshl_add_u32 v43, v7, 2, 1
v_add_u32 v44, 24, v6
v_cmp_gt_u32 vcc, v43, v44
v_mov_b32 v45, 0xce6e6b28
v_cndmask_b32 v69, v69, v45, vcc
v_max_f32 v41, v41, v69
v_cvt_pk_bf16_f32 v42, v70, v70
v_lshlrev_b32 v70, 16, v42
v_mul_f32 v70, 0x3d93cd3a, v70
v_cvt_pk_bf16_f32 v42, v70, v70
v_lshlrev_b32 v70, 16, v42
v_lshl_add_u32 v43, v7, 2, 2
v_add_u32 v44, 24, v6
v_cmp_gt_u32 vcc, v43, v44
v_mov_b32 v45, 0xce6e6b28
v_cndmask_b32 v70, v70, v45, vcc
v_max_f32 v41, v41, v70
v_cvt_pk_bf16_f32 v42, v71, v71
v_lshlrev_b32 v71, 16, v42
v_mul_f32 v71, 0x3d93cd3a, v71
v_cvt_pk_bf16_f32 v42, v71, v71
v_lshlrev_b32 v71, 16, v42
v_lshl_add_u32 v43, v7, 2, 3
v_add_u32 v44, 24, v6
v_cmp_gt_u32 vcc, v43, v44
v_mov_b32 v45, 0xce6e6b28
v_cndmask_b32 v71, v71, v45, vcc
v_max_f32 v41, v41, v71
v_cvt_pk_bf16_f32 v42, v76, v76
v_lshlrev_b32 v76, 16, v42
v_mul_f32 v76, 0x3d93cd3a, v76
v_cvt_pk_bf16_f32 v42, v76, v76
v_lshlrev_b32 v76, 16, v42
v_lshl_add_u32 v43, v7, 2, 16
v_add_u32 v44, 24, v6
v_cmp_gt_u32 vcc, v43, v44
v_mov_b32 v45, 0xce6e6b28
v_cndmask_b32 v76, v76, v45, vcc
v_max_f32 v41, v41, v76
v_cvt_pk_bf16_f32 v42, v77, v77
v_lshlrev_b32 v77, 16, v42
v_mul_f32 v77, 0x3d93cd3a, v77
v_cvt_pk_bf16_f32 v42, v77, v77
v_lshlrev_b32 v77, 16, v42
v_lshl_add_u32 v43, v7, 2, 17
v_add_u32 v44, 24, v6
v_cmp_gt_u32 vcc, v43, v44
v_mov_b32 v45, 0xce6e6b28
v_cndmask_b32 v77, v77, v45, vcc
v_max_f32 v41, v41, v77
v_cvt_pk_bf16_f32 v42, v78, v78
v_lshlrev_b32 v78, 16, v42
v_mul_f32 v78, 0x3d93cd3a, v78
v_cvt_pk_bf16_f32 v42, v78, v78
v_lshlrev_b32 v78, 16, v42
v_lshl_add_u32 v43, v7, 2, 18
v_add_u32 v44, 24, v6
v_cmp_gt_u32 vcc, v43, v44
v_mov_b32 v45, 0xce6e6b28
v_cndmask_b32 v78, v78, v45, vcc
v_max_f32 v41, v41, v78
v_cvt_pk_bf16_f32 v42, v79, v79
v_lshlrev_b32 v79, 16, v42
v_mul_f32 v79, 0x3d93cd3a, v79
v_cvt_pk_bf16_f32 v42, v79, v79
v_lshlrev_b32 v79, 16, v42
v_lshl_add_u32 v43, v7, 2, 19
v_add_u32 v44, 24, v6
v_cmp_gt_u32 vcc, v43, v44
v_mov_b32 v45, 0xce6e6b28
v_cndmask_b32 v79, v79, v45, vcc
v_max_f32 v41, v41, v79
v_cvt_pk_bf16_f32 v42, v84, v84
v_lshlrev_b32 v84, 16, v42
v_mul_f32 v84, 0x3d93cd3a, v84
v_cvt_pk_bf16_f32 v42, v84, v84
v_lshlrev_b32 v84, 16, v42
v_lshl_add_u32 v43, v7, 2, 32
v_add_u32 v44, 24, v6
v_cmp_gt_u32 vcc, v43, v44
v_mov_b32 v45, 0xce6e6b28
v_cndmask_b32 v84, v84, v45, vcc
v_max_f32 v41, v41, v84
v_cvt_pk_bf16_f32 v42, v85, v85
v_lshlrev_b32 v85, 16, v42
v_mul_f32 v85, 0x3d93cd3a, v85
v_cvt_pk_bf16_f32 v42, v85, v85
v_lshlrev_b32 v85, 16, v42
v_lshl_add_u32 v43, v7, 2, 33
v_add_u32 v44, 24, v6
v_cmp_gt_u32 vcc, v43, v44
v_mov_b32 v45, 0xce6e6b28
v_cndmask_b32 v85, v85, v45, vcc
v_max_f32 v41, v41, v85
v_cvt_pk_bf16_f32 v42, v86, v86
v_lshlrev_b32 v86, 16, v42
v_mul_f32 v86, 0x3d93cd3a, v86
v_cvt_pk_bf16_f32 v42, v86, v86
v_lshlrev_b32 v86, 16, v42
v_lshl_add_u32 v43, v7, 2, 34
v_add_u32 v44, 24, v6
v_cmp_gt_u32 vcc, v43, v44
v_mov_b32 v45, 0xce6e6b28
v_cndmask_b32 v86, v86, v45, vcc
v_max_f32 v41, v41, v86
v_cvt_pk_bf16_f32 v42, v87, v87
v_lshlrev_b32 v87, 16, v42
v_mul_f32 v87, 0x3d93cd3a, v87
v_cvt_pk_bf16_f32 v42, v87, v87
v_lshlrev_b32 v87, 16, v42
v_lshl_add_u32 v43, v7, 2, 35
v_add_u32 v44, 24, v6
v_cmp_gt_u32 vcc, v43, v44
v_mov_b32 v45, 0xce6e6b28
v_cndmask_b32 v87, v87, v45, vcc
v_max_f32 v41, v41, v87
v_xor_b32 v43, 64, v3
ds_bpermute_b32 v42, v43, v41
s_waitcnt lgkmcnt(0)
v_max_f32 v41, v41, v42
v_xor_b32 v43, 128, v3
ds_bpermute_b32 v42, v43, v41
s_waitcnt lgkmcnt(0)
v_max_f32 v41, v41, v42
v_mov_b32 v46, 0
v_sub_f32 v68, v68, v41
v_mul_f32 v68, 0x3fb8aa3b, v68
v_exp_f32 v68, v68
s_nop 0
v_add_f32 v46, v46, v68
v_sub_f32 v69, v69, v41
v_mul_f32 v69, 0x3fb8aa3b, v69
v_exp_f32 v69, v69
s_nop 0
v_add_f32 v46, v46, v69
v_sub_f32 v70, v70, v41
v_mul_f32 v70, 0x3fb8aa3b, v70
v_exp_f32 v70, v70
s_nop 0
v_add_f32 v46, v46, v70
v_sub_f32 v71, v71, v41
v_mul_f32 v71, 0x3fb8aa3b, v71
v_exp_f32 v71, v71
s_nop 0
v_add_f32 v46, v46, v71
v_sub_f32 v76, v76, v41
v_mul_f32 v76, 0x3fb8aa3b, v76
v_exp_f32 v76, v76
s_nop 0
v_add_f32 v46, v46, v76
v_sub_f32 v77, v77, v41
v_mul_f32 v77, 0x3fb8aa3b, v77
v_exp_f32 v77, v77
s_nop 0
v_add_f32 v46, v46, v77
v_sub_f32 v78, v78, v41
v_mul_f32 v78, 0x3fb8aa3b, v78
v_exp_f32 v78, v78
s_nop 0
v_add_f32 v46, v46, v78
v_sub_f32 v79, v79, v41
v_mul_f32 v79, 0x3fb8aa3b, v79
v_exp_f32 v79, v79
s_nop 0
v_add_f32 v46, v46, v79
v_sub_f32 v84, v84, v41
v_mul_f32 v84, 0x3fb8aa3b, v84
v_exp_f32 v84, v84
s_nop 0
v_add_f32 v46, v46, v84
v_sub_f32 v85, v85, v41
v_mul_f32 v85, 0x3fb8aa3b, v85
v_exp_f32 v85, v85
s_nop 0
v_add_f32 v46, v46, v85
v_sub_f32 v86, v86, v41
v_mul_f32 v86, 0x3fb8aa3b, v86
v_exp_f32 v86, v86
s_nop 0
v_add_f32 v46, v46, v86
v_sub_f32 v87, v87, v41
v_mul_f32 v87, 0x3fb8aa3b, v87
v_exp_f32 v87, v87
s_nop 0
v_add_f32 v46, v46, v87
v_xor_b32 v43, 64, v3
ds_bpermute_b32 v42, v43, v46
s_waitcnt lgkmcnt(0)
v_add_f32 v46, v46, v42
v_xor_b32 v43, 128, v3
ds_bpermute_b32 v42, v43, v46
s_waitcnt lgkmcnt(0)
v_add_f32 v46, v46, v42
v_rcp_f32 v46, v46
s_nop 0
v_mul_f32 v68, v68, v46
v_mul_f32 v69, v69, v46
v_mul_f32 v70, v70, v46
v_mul_f32 v71, v71, v46
v_cvt_pk_bf16_f32 v92, v68, v69
v_cvt_pk_bf16_f32 v93, v70, v71
v_mul_f32 v76, v76, v46
v_mul_f32 v77, v77, v46
v_mul_f32 v78, v78, v46
v_mul_f32 v79, v79, v46
v_cvt_pk_bf16_f32 v96, v76, v77
v_cvt_pk_bf16_f32 v97, v78, v79
v_mul_f32 v84, v84, v46
v_mul_f32 v85, v85, v46
v_mul_f32 v86, v86, v46
v_mul_f32 v87, v87, v46
v_cvt_pk_bf16_f32 v100, v84, v85
v_cvt_pk_bf16_f32 v101, v86, v87
v_lshl_add_u32 v10, v7, 2, 0
v_mul_u32_u24 v11, 192, v5
v_add_u32 v11, v11, v6
v_lshl_add_u32 v9, v4, 5, v10
v_add_u32 v9, -8, v9
v_min_u32 v9, 2044, v9
v_lshl_add_u32 v9, v11, 11, v9
v_lshlrev_b32 v9, 1, v9
v_add_u32 v9, 88342528, v9
v_mul_u32_u24 v44, 6144, v4
v_add_u32 v44, v44, v11
v_lshl_add_u32 v44, v44, 3, v10
v_lshlrev_b32 v44, 1, v44
v_add_u32 v44, 119799808, v44
v_cmp_gt_u32 vcc, 8, v10
v_mov_b32 v45, 65536
v_mov_b32 v47, 256
v_cndmask_b32 v104, v9, v44, vcc
v_cndmask_b32 v108, v45, v47, vcc
v_lshl_add_u32 v10, v7, 2, 16
v_mul_u32_u24 v11, 192, v5
v_add_u32 v11, v11, v6
v_lshl_add_u32 v9, v4, 5, v10
v_add_u32 v9, -8, v9
v_min_u32 v9, 2044, v9
v_lshl_add_u32 v9, v11, 11, v9
v_lshlrev_b32 v9, 1, v9
v_add_u32 v9, 88342528, v9
v_mul_u32_u24 v44, 6144, v4
v_add_u32 v44, v44, v11
v_lshl_add_u32 v44, v44, 3, v10
v_lshlrev_b32 v44, 1, v44
v_add_u32 v44, 119799808, v44
v_cmp_gt_u32 vcc, 8, v10
v_mov_b32 v45, 65536
v_mov_b32 v47, 256
v_cndmask_b32 v105, v9, v44, vcc
v_cndmask_b32 v109, v45, v47, vcc
v_lshl_add_u32 v10, v7, 2, 32
v_mul_u32_u24 v11, 192, v5
v_add_u32 v11, v11, v6
v_lshl_add_u32 v9, v4, 5, v10
v_add_u32 v9, -8, v9
v_min_u32 v9, 2044, v9
v_lshl_add_u32 v9, v11, 11, v9
v_lshlrev_b32 v9, 1, v9
v_add_u32 v9, 88342528, v9
v_mul_u32_u24 v44, 6144, v4
v_add_u32 v44, v44, v11
v_lshl_add_u32 v44, v44, 3, v10
v_lshlrev_b32 v44, 1, v44
v_add_u32 v44, 119799808, v44
v_cmp_gt_u32 vcc, 8, v10
v_mov_b32 v45, 65536
v_mov_b32 v47, 256
v_cndmask_b32 v106, v9, v44, vcc
v_cndmask_b32 v110, v45, v47, vcc
v_lshl_add_u32 v10, v4, 5, v6
v_mul_u32_u24 v10, 12288, v10
v_mul_u32_u24 v11, 384, v5
v_add_u32 v10, v10, v11
v_lshl_add_u32 v10, v7, 3, v10
v_add_u32 v10, 126091264, v10
buffer_load_dwordx2 v[20:21], v104, s[8:11], 0 offen
v_add_u32 v104, v104, v108
buffer_load_dwordx2 v[22:23], v105, s[8:11], 0 offen
v_add_u32 v105, v105, v109
buffer_load_dwordx2 v[24:25], v106, s[8:11], 0 offen
v_add_u32 v106, v106, v110
v_mov_b32 v30, 0
v_mov_b32 v31, 0
v_mov_b32 v32, 0
v_mov_b32 v33, 0
v_mov_b32 v34, 0
v_mov_b32 v35, 0
v_mov_b32 v36, 0
v_mov_b32 v37, 0
s_waitcnt vmcnt(0)
v_mfma_f32_16x16x16_bf16 v[30:33], v[20:21], v[90:91], v[30:33]
v_mfma_f32_16x16x16_bf16 v[34:37], v[20:21], v[92:93], v[34:37]
v_mfma_f32_16x16x16_bf16 v[30:33], v[22:23], v[94:95], v[30:33]
v_mfma_f32_16x16x16_bf16 v[34:37], v[22:23], v[96:97], v[34:37]
v_mfma_f32_16x16x16_bf16 v[30:33], v[24:25], v[98:99], v[30:33]
v_mfma_f32_16x16x16_bf16 v[34:37], v[24:25], v[100:101], v[34:37]
s_nop 7
v_cvt_pk_bf16_f32 v38, v30, v31
v_cvt_pk_bf16_f32 v39, v32, v33
buffer_store_dwordx2 v[38:39], v10, s[8:11], 0 offen offset:0
v_add_u32 v11, 196608, v10
v_cvt_pk_bf16_f32 v38, v34, v35
v_cvt_pk_bf16_f32 v39, v36, v37
buffer_store_dwordx2 v[38:39], v11, s[8:11], 0 offen offset:0
buffer_load_dwordx2 v[20:21], v104, s[8:11], 0 offen
v_add_u32 v104, v104, v108
buffer_load_dwordx2 v[22:23], v105, s[8:11], 0 offen
v_add_u32 v105, v105, v109
buffer_load_dwordx2 v[24:25], v106, s[8:11], 0 offen
v_add_u32 v106, v106, v110
v_mov_b32 v30, 0
v_mov_b32 v31, 0
v_mov_b32 v32, 0
v_mov_b32 v33, 0
v_mov_b32 v34, 0
v_mov_b32 v35, 0
v_mov_b32 v36, 0
v_mov_b32 v37, 0
s_waitcnt vmcnt(0)
v_mfma_f32_16x16x16_bf16 v[30:33], v[20:21], v[90:91], v[30:33]
v_mfma_f32_16x16x16_bf16 v[34:37], v[20:21], v[92:93], v[34:37]
v_mfma_f32_16x16x16_bf16 v[30:33], v[22:23], v[94:95], v[30:33]
v_mfma_f32_16x16x16_bf16 v[34:37], v[22:23], v[96:97], v[34:37]
v_mfma_f32_16x16x16_bf16 v[30:33], v[24:25], v[98:99], v[30:33]
v_mfma_f32_16x16x16_bf16 v[34:37], v[24:25], v[100:101], v[34:37]
s_nop 7
v_cvt_pk_bf16_f32 v38, v30, v31
v_cvt_pk_bf16_f32 v39, v32, v33
buffer_store_dwordx2 v[38:39], v10, s[8:11], 0 offen offset:32
v_add_u32 v11, 196608, v10
v_cvt_pk_bf16_f32 v38, v34, v35
v_cvt_pk_bf16_f32 v39, v36, v37
buffer_store_dwordx2 v[38:39], v11, s[8:11], 0 offen offset:32
buffer_load_dwordx2 v[20:21], v104, s[8:11], 0 offen
v_add_u32 v104, v104, v108
buffer_load_dwordx2 v[22:23], v105, s[8:11], 0 offen
v_add_u32 v105, v105, v109
buffer_load_dwordx2 v[24:25], v106, s[8:11], 0 offen
v_add_u32 v106, v106, v110
v_mov_b32 v30, 0
v_mov_b32 v31, 0
v_mov_b32 v32, 0
v_mov_b32 v33, 0
v_mov_b32 v34, 0
v_mov_b32 v35, 0
v_mov_b32 v36, 0
v_mov_b32 v37, 0
s_waitcnt vmcnt(0)
v_mfma_f32_16x16x16_bf16 v[30:33], v[20:21], v[90:91], v[30:33]
v_mfma_f32_16x16x16_bf16 v[34:37], v[20:21], v[92:93], v[34:37]
v_mfma_f32_16x16x16_bf16 v[30:33], v[22:23], v[94:95], v[30:33]
v_mfma_f32_16x16x16_bf16 v[34:37], v[22:23], v[96:97], v[34:37]
v_mfma_f32_16x16x16_bf16 v[30:33], v[24:25], v[98:99], v[30:33]
v_mfma_f32_16x16x16_bf16 v[34:37], v[24:25], v[100:101], v[34:37]
s_nop 7
v_cvt_pk_bf16_f32 v38, v30, v31
v_cvt_pk_bf16_f32 v39, v32, v33
buffer_store_dwordx2 v[38:39], v10, s[8:11], 0 offen offset:64
v_add_u32 v11, 196608, v10
v_cvt_pk_bf16_f32 v38, v34, v35
v_cvt_pk_bf16_f32 v39, v36, v37
buffer_store_dwordx2 v[38:39], v11, s[8:11], 0 offen offset:64
buffer_load_dwordx2 v[20:21], v104, s[8:11], 0 offen
v_add_u32 v104, v104, v108
buffer_load_dwordx2 v[22:23], v105, s[8:11], 0 offen
v_add_u32 v105, v105, v109
buffer_load_dwordx2 v[24:25], v106, s[8:11], 0 offen
v_add_u32 v106, v106, v110
v_mov_b32 v30, 0
v_mov_b32 v31, 0
v_mov_b32 v32, 0
v_mov_b32 v33, 0
v_mov_b32 v34, 0
v_mov_b32 v35, 0
v_mov_b32 v36, 0
v_mov_b32 v37, 0
s_waitcnt vmcnt(0)
v_mfma_f32_16x16x16_bf16 v[30:33], v[20:21], v[90:91], v[30:33]
v_mfma_f32_16x16x16_bf16 v[34:37], v[20:21], v[92:93], v[34:37]
v_mfma_f32_16x16x16_bf16 v[30:33], v[22:23], v[94:95], v[30:33]
v_mfma_f32_16x16x16_bf16 v[34:37], v[22:23], v[96:97], v[34:37]
v_mfma_f32_16x16x16_bf16 v[30:33], v[24:25], v[98:99], v[30:33]
v_mfma_f32_16x16x16_bf16 v[34:37], v[24:25], v[100:101], v[34:37]
s_nop 7
v_cvt_pk_bf16_f32 v38, v30, v31
v_cvt_pk_bf16_f32 v39, v32, v33
buffer_store_dwordx2 v[38:39], v10, s[8:11], 0 offen offset:96
v_add_u32 v11, 196608, v10
v_cvt_pk_bf16_f32 v38, v34, v35
v_cvt_pk_bf16_f32 v39, v36, v37
buffer_store_dwordx2 v[38:39], v11, s[8:11], 0 offen offset:96
buffer_load_dwordx2 v[20:21], v104, s[8:11], 0 offen
v_add_u32 v104, v104, v108
buffer_load_dwordx2 v[22:23], v105, s[8:11], 0 offen
v_add_u32 v105, v105, v109
buffer_load_dwordx2 v[24:25], v106, s[8:11], 0 offen
v_add_u32 v106, v106, v110
v_mov_b32 v30, 0
v_mov_b32 v31, 0
v_mov_b32 v32, 0
v_mov_b32 v33, 0
v_mov_b32 v34, 0
v_mov_b32 v35, 0
v_mov_b32 v36, 0
v_mov_b32 v37, 0
s_waitcnt vmcnt(0)
v_mfma_f32_16x16x16_bf16 v[30:33], v[20:21], v[90:91], v[30:33]
v_mfma_f32_16x16x16_bf16 v[34:37], v[20:21], v[92:93], v[34:37]
v_mfma_f32_16x16x16_bf16 v[30:33], v[22:23], v[94:95], v[30:33]
v_mfma_f32_16x16x16_bf16 v[34:37], v[22:23], v[96:97], v[34:37]
v_mfma_f32_16x16x16_bf16 v[30:33], v[24:25], v[98:99], v[30:33]
v_mfma_f32_16x16x16_bf16 v[34:37], v[24:25], v[100:101], v[34:37]
s_nop 7
v_cvt_pk_bf16_f32 v38, v30, v31
v_cvt_pk_bf16_f32 v39, v32, v33
buffer_store_dwordx2 v[38:39], v10, s[8:11], 0 offen offset:128
v_add_u32 v11, 196608, v10
v_cvt_pk_bf16_f32 v38, v34, v35
v_cvt_pk_bf16_f32 v39, v36, v37
buffer_store_dwordx2 v[38:39], v11, s[8:11], 0 offen offset:128
buffer_load_dwordx2 v[20:21], v104, s[8:11], 0 offen
v_add_u32 v104, v104, v108
buffer_load_dwordx2 v[22:23], v105, s[8:11], 0 offen
v_add_u32 v105, v105, v109
buffer_load_dwordx2 v[24:25], v106, s[8:11], 0 offen
v_add_u32 v106, v106, v110
v_mov_b32 v30, 0
v_mov_b32 v31, 0
v_mov_b32 v32, 0
v_mov_b32 v33, 0
v_mov_b32 v34, 0
v_mov_b32 v35, 0
v_mov_b32 v36, 0
v_mov_b32 v37, 0
s_waitcnt vmcnt(0)
v_mfma_f32_16x16x16_bf16 v[30:33], v[20:21], v[90:91], v[30:33]
v_mfma_f32_16x16x16_bf16 v[34:37], v[20:21], v[92:93], v[34:37]
v_mfma_f32_16x16x16_bf16 v[30:33], v[22:23], v[94:95], v[30:33]
v_mfma_f32_16x16x16_bf16 v[34:37], v[22:23], v[96:97], v[34:37]
v_mfma_f32_16x16x16_bf16 v[30:33], v[24:25], v[98:99], v[30:33]
v_mfma_f32_16x16x16_bf16 v[34:37], v[24:25], v[100:101], v[34:37]
s_nop 7
v_cvt_pk_bf16_f32 v38, v30, v31
v_cvt_pk_bf16_f32 v39, v32, v33
buffer_store_dwordx2 v[38:39], v10, s[8:11], 0 offen offset:160
v_add_u32 v11, 196608, v10
v_cvt_pk_bf16_f32 v38, v34, v35
v_cvt_pk_bf16_f32 v39, v36, v37
buffer_store_dwordx2 v[38:39], v11, s[8:11], 0 offen offset:160
buffer_load_dwordx2 v[20:21], v104, s[8:11], 0 offen
v_add_u32 v104, v104, v108
buffer_load_dwordx2 v[22:23], v105, s[8:11], 0 offen
v_add_u32 v105, v105, v109
buffer_load_dwordx2 v[24:25], v106, s[8:11], 0 offen
v_add_u32 v106, v106, v110
v_mov_b32 v30, 0
v_mov_b32 v31, 0
v_mov_b32 v32, 0
v_mov_b32 v33, 0
v_mov_b32 v34, 0
v_mov_b32 v35, 0
v_mov_b32 v36, 0
v_mov_b32 v37, 0
s_waitcnt vmcnt(0)
v_mfma_f32_16x16x16_bf16 v[30:33], v[20:21], v[90:91], v[30:33]
v_mfma_f32_16x16x16_bf16 v[34:37], v[20:21], v[92:93], v[34:37]
v_mfma_f32_16x16x16_bf16 v[30:33], v[22:23], v[94:95], v[30:33]
v_mfma_f32_16x16x16_bf16 v[34:37], v[22:23], v[96:97], v[34:37]
v_mfma_f32_16x16x16_bf16 v[30:33], v[24:25], v[98:99], v[30:33]
v_mfma_f32_16x16x16_bf16 v[34:37], v[24:25], v[100:101], v[34:37]
s_nop 7
v_cvt_pk_bf16_f32 v38, v30, v31
v_cvt_pk_bf16_f32 v39, v32, v33
buffer_store_dwordx2 v[38:39], v10, s[8:11], 0 offen offset:192
v_add_u32 v11, 196608, v10
v_cvt_pk_bf16_f32 v38, v34, v35
v_cvt_pk_bf16_f32 v39, v36, v37
buffer_store_dwordx2 v[38:39], v11, s[8:11], 0 offen offset:192
buffer_load_dwordx2 v[20:21], v104, s[8:11], 0 offen
v_add_u32 v104, v104, v108
buffer_load_dwordx2 v[22:23], v105, s[8:11], 0 offen
v_add_u32 v105, v105, v109
buffer_load_dwordx2 v[24:25], v106, s[8:11], 0 offen
v_add_u32 v106, v106, v110
v_mov_b32 v30, 0
v_mov_b32 v31, 0
v_mov_b32 v32, 0
v_mov_b32 v33, 0
v_mov_b32 v34, 0
v_mov_b32 v35, 0
v_mov_b32 v36, 0
v_mov_b32 v37, 0
s_waitcnt vmcnt(0)
v_mfma_f32_16x16x16_bf16 v[30:33], v[20:21], v[90:91], v[30:33]
v_mfma_f32_16x16x16_bf16 v[34:37], v[20:21], v[92:93], v[34:37]
v_mfma_f32_16x16x16_bf16 v[30:33], v[22:23], v[94:95], v[30:33]
v_mfma_f32_16x16x16_bf16 v[34:37], v[22:23], v[96:97], v[34:37]
v_mfma_f32_16x16x16_bf16 v[30:33], v[24:25], v[98:99], v[30:33]
v_mfma_f32_16x16x16_bf16 v[34:37], v[24:25], v[100:101], v[34:37]
s_nop 7
v_cvt_pk_bf16_f32 v38, v30, v31
v_cvt_pk_bf16_f32 v39, v32, v33
buffer_store_dwordx2 v[38:39], v10, s[8:11], 0 offen offset:224
v_add_u32 v11, 196608, v10
v_cvt_pk_bf16_f32 v38, v34, v35
v_cvt_pk_bf16_f32 v39, v36, v37
buffer_store_dwordx2 v[38:39], v11, s[8:11], 0 offen offset:224
buffer_load_dwordx2 v[20:21], v104, s[8:11], 0 offen
v_add_u32 v104, v104, v108
buffer_load_dwordx2 v[22:23], v105, s[8:11], 0 offen
v_add_u32 v105, v105, v109
buffer_load_dwordx2 v[24:25], v106, s[8:11], 0 offen
v_add_u32 v106, v106, v110
v_mov_b32 v30, 0
v_mov_b32 v31, 0
v_mov_b32 v32, 0
v_mov_b32 v33, 0
v_mov_b32 v34, 0
v_mov_b32 v35, 0
v_mov_b32 v36, 0
v_mov_b32 v37, 0
s_waitcnt vmcnt(0)
v_mfma_f32_16x16x16_bf16 v[30:33], v[20:21], v[90:91], v[30:33]
v_mfma_f32_16x16x16_bf16 v[34:37], v[20:21], v[92:93], v[34:37]
v_mfma_f32_16x16x16_bf16 v[30:33], v[22:23], v[94:95], v[30:33]
v_mfma_f32_16x16x16_bf16 v[34:37], v[22:23], v[96:97], v[34:37]
v_mfma_f32_16x16x16_bf16 v[30:33], v[24:25], v[98:99], v[30:33]
v_mfma_f32_16x16x16_bf16 v[34:37], v[24:25], v[100:101], v[34:37]
s_nop 7
v_cvt_pk_bf16_f32 v38, v30, v31
v_cvt_pk_bf16_f32 v39, v32, v33
buffer_store_dwordx2 v[38:39], v10, s[8:11], 0 offen offset:256
v_add_u32 v11, 196608, v10
v_cvt_pk_bf16_f32 v38, v34, v35
v_cvt_pk_bf16_f32 v39, v36, v37
buffer_store_dwordx2 v[38:39], v11, s[8:11], 0 offen offset:256
buffer_load_dwordx2 v[20:21], v104, s[8:11], 0 offen
v_add_u32 v104, v104, v108
buffer_load_dwordx2 v[22:23], v105, s[8:11], 0 offen
v_add_u32 v105, v105, v109
buffer_load_dwordx2 v[24:25], v106, s[8:11], 0 offen
v_add_u32 v106, v106, v110
v_mov_b32 v30, 0
v_mov_b32 v31, 0
v_mov_b32 v32, 0
v_mov_b32 v33, 0
v_mov_b32 v34, 0
v_mov_b32 v35, 0
v_mov_b32 v36, 0
v_mov_b32 v37, 0
s_waitcnt vmcnt(0)
v_mfma_f32_16x16x16_bf16 v[30:33], v[20:21], v[90:91], v[30:33]
v_mfma_f32_16x16x16_bf16 v[34:37], v[20:21], v[92:93], v[34:37]
v_mfma_f32_16x16x16_bf16 v[30:33], v[22:23], v[94:95], v[30:33]
v_mfma_f32_16x16x16_bf16 v[34:37], v[22:23], v[96:97], v[34:37]
v_mfma_f32_16x16x16_bf16 v[30:33], v[24:25], v[98:99], v[30:33]
v_mfma_f32_16x16x16_bf16 v[34:37], v[24:25], v[100:101], v[34:37]
s_nop 7
v_cvt_pk_bf16_f32 v38, v30, v31
v_cvt_pk_bf16_f32 v39, v32, v33
buffer_store_dwordx2 v[38:39], v10, s[8:11], 0 offen offset:288
v_add_u32 v11, 196608, v10
v_cvt_pk_bf16_f32 v38, v34, v35
v_cvt_pk_bf16_f32 v39, v36, v37
buffer_store_dwordx2 v[38:39], v11, s[8:11], 0 offen offset:288
buffer_load_dwordx2 v[20:21], v104, s[8:11], 0 offen
v_add_u32 v104, v104, v108
buffer_load_dwordx2 v[22:23], v105, s[8:11], 0 offen
v_add_u32 v105, v105, v109
buffer_load_dwordx2 v[24:25], v106, s[8:11], 0 offen
v_add_u32 v106, v106, v110
v_mov_b32 v30, 0
v_mov_b32 v31, 0
v_mov_b32 v32, 0
v_mov_b32 v33, 0
v_mov_b32 v34, 0
v_mov_b32 v35, 0
v_mov_b32 v36, 0
v_mov_b32 v37, 0
s_waitcnt vmcnt(0)
v_mfma_f32_16x16x16_bf16 v[30:33], v[20:21], v[90:91], v[30:33]
v_mfma_f32_16x16x16_bf16 v[34:37], v[20:21], v[92:93], v[34:37]
v_mfma_f32_16x16x16_bf16 v[30:33], v[22:23], v[94:95], v[30:33]
v_mfma_f32_16x16x16_bf16 v[34:37], v[22:23], v[96:97], v[34:37]
v_mfma_f32_16x16x16_bf16 v[30:33], v[24:25], v[98:99], v[30:33]
v_mfma_f32_16x16x16_bf16 v[34:37], v[24:25], v[100:101], v[34:37]
s_nop 7
v_cvt_pk_bf16_f32 v38, v30, v31
v_cvt_pk_bf16_f32 v39, v32, v33
buffer_store_dwordx2 v[38:39], v10, s[8:11], 0 offen offset:320
v_add_u32 v11, 196608, v10
v_cvt_pk_bf16_f32 v38, v34, v35
v_cvt_pk_bf16_f32 v39, v36, v37
buffer_store_dwordx2 v[38:39], v11, s[8:11], 0 offen offset:320
buffer_load_dwordx2 v[20:21], v104, s[8:11], 0 offen
v_add_u32 v104, v104, v108
buffer_load_dwordx2 v[22:23], v105, s[8:11], 0 offen
v_add_u32 v105, v105, v109
buffer_load_dwordx2 v[24:25], v106, s[8:11], 0 offen
v_add_u32 v106, v106, v110
v_mov_b32 v30, 0
v_mov_b32 v31, 0
v_mov_b32 v32, 0
v_mov_b32 v33, 0
v_mov_b32 v34, 0
v_mov_b32 v35, 0
v_mov_b32 v36, 0
v_mov_b32 v37, 0
s_waitcnt vmcnt(0)
v_mfma_f32_16x16x16_bf16 v[30:33], v[20:21], v[90:91], v[30:33]
v_mfma_f32_16x16x16_bf16 v[34:37], v[20:21], v[92:93], v[34:37]
v_mfma_f32_16x16x16_bf16 v[30:33], v[22:23], v[94:95], v[30:33]
v_mfma_f32_16x16x16_bf16 v[34:37], v[22:23], v[96:97], v[34:37]
v_mfma_f32_16x16x16_bf16 v[30:33], v[24:25], v[98:99], v[30:33]
v_mfma_f32_16x16x16_bf16 v[34:37], v[24:25], v[100:101], v[34:37]
s_nop 7
v_cvt_pk_bf16_f32 v38, v30, v31
v_cvt_pk_bf16_f32 v39, v32, v33
buffer_store_dwordx2 v[38:39], v10, s[8:11], 0 offen offset:352
v_add_u32 v11, 196608, v10
v_cvt_pk_bf16_f32 v38, v34, v35
v_cvt_pk_bf16_f32 v39, v36, v37
buffer_store_dwordx2 v[38:39], v11, s[8:11], 0 offen offset:352
at_kernel_e:
s_endpgm
.p2align 8
g2_kernel:
s_cmp_ge_u32 s2, 320
s_cbranch_scc1 g2_kernel_e
s_load_dwordx2 s[90:91], s[0:1], 112
s_waitcnt lgkmcnt(0)
s_add_u32 s8, s90, 126091264
s_addc_u32 s9, s91, 0
s_mov_b32 s10, 25165824
s_mov_b32 s11, 0x00020000
s_load_dwordx2 s[90:91], s[0:1], 112
s_waitcnt lgkmcnt(0)
s_add_u32 s12, s90, 26214400
s_addc_u32 s13, s91, 0
s_mov_b32 s14, 7864320
s_mov_b32 s15, 0x00020000
s_and_b32 s24, s2, 31
s_lshr_b32 s25, s2, 5
s_mul_i32 s26, s24, 786432
s_mul_i32 s27, s25, 786432
v_add_u32 v2, 0, v0
v_lshrrev_b32 v3, 3, v2
v_and_b32 v4, 7, v2
v_mul_u32_u24 v5, 12288, v3
v_lshl_add_u32 v5, v4, 4, v5
v_add_u32 v128, s26, v5
v_add_u32 v132, s27, v5
v_mul_u32_u24 v5, 144, v3
v_lshl_add_u32 v136, v4, 4, v5
v_add_u32 v2, 256, v0
v_lshrrev_b32 v3, 3, v2
v_and_b32 v4, 7, v2
v_mul_u32_u24 v5, 12288, v3
v_lshl_add_u32 v5, v4, 4, v5
v_add_u32 v129, s26, v5
v_add_u32 v133, s27, v5
v_mul_u32_u24 v5, 144, v3
v_lshl_add_u32 v137, v4, 4, v5
v_lshrrev_b32 v2, 6, v0
v_and_b32 v3, 63, v0
v_lshrrev_b32 v4, 1, v2
v_and_b32 v5, 1, v2
v_and_b32 v6, 31, v3
v_lshrrev_b32 v7, 5, v3
v_mul_u32_u24 v140, 32, v4
v_add_u32 v140, v140, v6
v_mul_u32_u24 v140, 144, v140
v_lshl_add_u32 v140, v7, 4, v140
v_mul_u32_u24 v141, 32, v5
v_add_u32 v141, v141, v6
v_mul_u32_u24 v141, 144, v141
v_lshl_add_u32 v141, v7, 4, v141
v_add_u32 v141, 9216, v141
v_mov_b32 v64, 0
v_mov_b32 v65, 0
v_mov_b32 v66, 0
v_mov_b32 v67, 0
v_mov_b32 v68, 0
v_mov_b32 v69, 0
v_mov_b32 v70, 0
v_mov_b32 v71, 0
v_mov_b32 v72, 0
v_mov_b32 v73, 0
v_mov_b32 v74, 0
v_mov_b32 v75, 0
v_mov_b32 v76, 0
v_mov_b32 v77, 0
v_mov_b32 v78, 0
v_mov_b32 v79, 0
s_mov_b32 s28, 0
buffer_load_dwordx4 v[32:35], v128, s[8:11], s28 offen
buffer_load_dwordx4 v[48:51], v132, s[12:15], s28 offen
buffer_load_dwordx4 v[36:39], v129, s[8:11], s28 offen
buffer_load_dwordx4 v[52:55], v133, s[12:15], s28 offen
g2_kernel_l:
s_waitcnt vmcnt(0)
ds_write_b128 v136, v[32:35]
ds_write_b128 v136, v[48:51] offset:9216
ds_write_b128 v137, v[36:39]
ds_write_b128 v137, v[52:55] offset:9216
s_waitcnt lgkmcnt(0)
s_barrier
s_add_u32 s28, s28, 128
buffer_load_dwordx4 v[32:35], v128, s[8:11], s28 offen
buffer_load_dwordx4 v[48:51], v132, s[12:15], s28 offen
buffer_load_dwordx4 v[36:39], v129, s[8:11], s28 offen
buffer_load_dwordx4 v[52:55], v133, s[12:15], s28 offen
ds_read_b128 v[8:11], v140 offset:0
ds_read_b128 v[16:19], v141 offset:0
s_waitcnt lgkmcnt(0)
v_mfma_f32_32x32x16_bf16 v[64:79], v[8:11], v[16:19], v[64:79]
ds_read_b128 v[8:11], v140 offset:32
ds_read_b128 v[16:19], v141 offset:32
s_waitcnt lgkmcnt(0)
v_mfma_f32_32x32x16_bf16 v[64:79], v[8:11], v[16:19], v[64:79]
ds_read_b128 v[8:11], v140 offset:64
ds_read_b128 v[16:19], v141 offset:64
s_waitcnt lgkmcnt(0)
v_mfma_f32_32x32x16_bf16 v[64:79], v[8:11], v[16:19], v[64:79]
ds_read_b128 v[8:11], v140 offset:96
ds_read_b128 v[16:19], v141 offset:96
s_waitcnt lgkmcnt(0)
v_mfma_f32_32x32x16_bf16 v[64:79], v[8:11], v[16:19], v[64:79]
s_barrier
s_cmp_lt_u32 s28, 12288
s_cbranch_scc1 g2_kernel_l
s_nop 15
s_waitcnt vmcnt(0)
s_mul_i32 s26, s24, 64
s_mul_i32 s27, s25, 64
v_mul_u32_u24 v8, 32, v4
v_lshl_add_u32 v8, v7, 2, v8
v_add_u32 v8, s26, v8
v_mul_u32_u24 v9, 32, v5
v_add_u32 v9, v9, v6
v_add_u32 v9, s27, v9
s_load_dwordx2 s[90:91], s[0:1], 112
s_waitcnt lgkmcnt(0)
s_add_u32 s16, s90, 151257088
s_addc_u32 s17, s91, 0
s_mov_b32 s18, 2621440
s_mov_b32 s19, 0x00020000
s_load_dwordx2 s[90:91], s[0:1], 0
s_waitcnt lgkmcnt(0)
s_add_u32 s20, s90, 0
s_addc_u32 s21, s91, 0
s_mov_b32 s22, 2621440
s_mov_b32 s23, 0x00020000
v_add_u32 v11, 0, v9
v_lshlrev_b32 v11, 1, v11
v_add_u32 v10, 0, v8
v_mul_u32_u24 v10, 1280, v10
v_add_u32 v10, v10, v11
v_cvt_pk_bf16_f32 v12, v64, v64
v_lshlrev_b32 v64, 16, v12
buffer_load_ushort v15, v10, s[20:23], 0 offen
s_waitcnt vmcnt(0)
v_lshlrev_b32 v15, 16, v15
v_add_f32 v64, v64, v15
v_cvt_pk_bf16_f32 v12, v64, v64
buffer_store_short v12, v10, s[16:19], 0 offen
v_add_u32 v10, 1, v8
v_mul_u32_u24 v10, 1280, v10
v_add_u32 v10, v10, v11
v_cvt_pk_bf16_f32 v12, v65, v65
v_lshlrev_b32 v65, 16, v12
buffer_load_ushort v15, v10, s[20:23], 0 offen
s_waitcnt vmcnt(0)
v_lshlrev_b32 v15, 16, v15
v_add_f32 v65, v65, v15
v_cvt_pk_bf16_f32 v12, v65, v65
buffer_store_short v12, v10, s[16:19], 0 offen
v_add_u32 v10, 2, v8
v_mul_u32_u24 v10, 1280, v10
v_add_u32 v10, v10, v11
v_cvt_pk_bf16_f32 v12, v66, v66
v_lshlrev_b32 v66, 16, v12
buffer_load_ushort v15, v10, s[20:23], 0 offen
s_waitcnt vmcnt(0)
v_lshlrev_b32 v15, 16, v15
v_add_f32 v66, v66, v15
v_cvt_pk_bf16_f32 v12, v66, v66
buffer_store_short v12, v10, s[16:19], 0 offen
v_add_u32 v10, 3, v8
v_mul_u32_u24 v10, 1280, v10
v_add_u32 v10, v10, v11
v_cvt_pk_bf16_f32 v12, v67, v67
v_lshlrev_b32 v67, 16, v12
buffer_load_ushort v15, v10, s[20:23], 0 offen
s_waitcnt vmcnt(0)
v_lshlrev_b32 v15, 16, v15
v_add_f32 v67, v67, v15
v_cvt_pk_bf16_f32 v12, v67, v67
buffer_store_short v12, v10, s[16:19], 0 offen
v_add_u32 v10, 8, v8
v_mul_u32_u24 v10, 1280, v10
v_add_u32 v10, v10, v11
v_cvt_pk_bf16_f32 v12, v68, v68
v_lshlrev_b32 v68, 16, v12
buffer_load_ushort v15, v10, s[20:23], 0 offen
s_waitcnt vmcnt(0)
v_lshlrev_b32 v15, 16, v15
v_add_f32 v68, v68, v15
v_cvt_pk_bf16_f32 v12, v68, v68
buffer_store_short v12, v10, s[16:19], 0 offen
v_add_u32 v10, 9, v8
v_mul_u32_u24 v10, 1280, v10
v_add_u32 v10, v10, v11
v_cvt_pk_bf16_f32 v12, v69, v69
v_lshlrev_b32 v69, 16, v12
buffer_load_ushort v15, v10, s[20:23], 0 offen
s_waitcnt vmcnt(0)
v_lshlrev_b32 v15, 16, v15
v_add_f32 v69, v69, v15
v_cvt_pk_bf16_f32 v12, v69, v69
buffer_store_short v12, v10, s[16:19], 0 offen
v_add_u32 v10, 10, v8
v_mul_u32_u24 v10, 1280, v10
v_add_u32 v10, v10, v11
v_cvt_pk_bf16_f32 v12, v70, v70
v_lshlrev_b32 v70, 16, v12
buffer_load_ushort v15, v10, s[20:23], 0 offen
s_waitcnt vmcnt(0)
v_lshlrev_b32 v15, 16, v15
v_add_f32 v70, v70, v15
v_cvt_pk_bf16_f32 v12, v70, v70
buffer_store_short v12, v10, s[16:19], 0 offen
v_add_u32 v10, 11, v8
v_mul_u32_u24 v10, 1280, v10
v_add_u32 v10, v10, v11
v_cvt_pk_bf16_f32 v12, v71, v71
v_lshlrev_b32 v71, 16, v12
buffer_load_ushort v15, v10, s[20:23], 0 offen
s_waitcnt vmcnt(0)
v_lshlrev_b32 v15, 16, v15
v_add_f32 v71, v71, v15
v_cvt_pk_bf16_f32 v12, v71, v71
buffer_store_short v12, v10, s[16:19], 0 offen
v_add_u32 v10, 16, v8
v_mul_u32_u24 v10, 1280, v10
v_add_u32 v10, v10, v11
v_cvt_pk_bf16_f32 v12, v72, v72
v_lshlrev_b32 v72, 16, v12
buffer_load_ushort v15, v10, s[20:23], 0 offen
s_waitcnt vmcnt(0)
v_lshlrev_b32 v15, 16, v15
v_add_f32 v72, v72, v15
v_cvt_pk_bf16_f32 v12, v72, v72
buffer_store_short v12, v10, s[16:19], 0 offen
v_add_u32 v10, 17, v8
v_mul_u32_u24 v10, 1280, v10
v_add_u32 v10, v10, v11
v_cvt_pk_bf16_f32 v12, v73, v73
v_lshlrev_b32 v73, 16, v12
buffer_load_ushort v15, v10, s[20:23], 0 offen
s_waitcnt vmcnt(0)
v_lshlrev_b32 v15, 16, v15
v_add_f32 v73, v73, v15
v_cvt_pk_bf16_f32 v12, v73, v73
buffer_store_short v12, v10, s[16:19], 0 offen
v_add_u32 v10, 18, v8
v_mul_u32_u24 v10, 1280, v10
v_add_u32 v10, v10, v11
v_cvt_pk_bf16_f32 v12, v74, v74
v_lshlrev_b32 v74, 16, v12
buffer_load_ushort v15, v10, s[20:23], 0 offen
s_waitcnt vmcnt(0)
v_lshlrev_b32 v15, 16, v15
v_add_f32 v74, v74, v15
v_cvt_pk_bf16_f32 v12, v74, v74
buffer_store_short v12, v10, s[16:19], 0 offen
v_add_u32 v10, 19, v8
v_mul_u32_u24 v10, 1280, v10
v_add_u32 v10, v10, v11
v_cvt_pk_bf16_f32 v12, v75, v75
v_lshlrev_b32 v75, 16, v12
buffer_load_ushort v15, v10, s[20:23], 0 offen
s_waitcnt vmcnt(0)
v_lshlrev_b32 v15, 16, v15
v_add_f32 v75, v75, v15
v_cvt_pk_bf16_f32 v12, v75, v75
buffer_store_short v12, v10, s[16:19], 0 offen
v_add_u32 v10, 24, v8
v_mul_u32_u24 v10, 1280, v10
v_add_u32 v10, v10, v11
v_cvt_pk_bf16_f32 v12, v76, v76
v_lshlrev_b32 v76, 16, v12
buffer_load_ushort v15, v10, s[20:23], 0 offen
s_waitcnt vmcnt(0)
v_lshlrev_b32 v15, 16, v15
v_add_f32 v76, v76, v15
v_cvt_pk_bf16_f32 v12, v76, v76
buffer_store_short v12, v10, s[16:19], 0 offen
v_add_u32 v10, 25, v8
v_mul_u32_u24 v10, 1280, v10
v_add_u32 v10, v10, v11
v_cvt_pk_bf16_f32 v12, v77, v77
v_lshlrev_b32 v77, 16, v12
buffer_load_ushort v15, v10, s[20:23], 0 offen
s_waitcnt vmcnt(0)
v_lshlrev_b32 v15, 16, v15
v_add_f32 v77, v77, v15
v_cvt_pk_bf16_f32 v12, v77, v77
buffer_store_short v12, v10, s[16:19], 0 offen
v_add_u32 v10, 26, v8
v_mul_u32_u24 v10, 1280, v10
v_add_u32 v10, v10, v11
v_cvt_pk_bf16_f32 v12, v78, v78
v_lshlrev_b32 v78, 16, v12
buffer_load_ushort v15, v10, s[20:23], 0 offen
s_waitcnt vmcnt(0)
v_lshlrev_b32 v15, 16, v15
v_add_f32 v78, v78, v15
v_cvt_pk_bf16_f32 v12, v78, v78
buffer_store_short v12, v10, s[16:19], 0 offen
v_add_u32 v10, 27, v8
v_mul_u32_u24 v10, 1280, v10
v_add_u32 v10, v10, v11
v_cvt_pk_bf16_f32 v12, v79, v79
v_lshlrev_b32 v79, 16, v12
buffer_load_ushort v15, v10, s[20:23], 0 offen
s_waitcnt vmcnt(0)
v_lshlrev_b32 v15, 16, v15
v_add_f32 v79, v79, v15
v_cvt_pk_bf16_f32 v12, v79, v79
buffer_store_short v12, v10, s[16:19], 0 offen
g2_kernel_e:
s_endpgm
.p2align 8
ln2_kernel:
s_cmp_ge_u32 s2, 512
s_cbranch_scc1 ln2_kernel_e
s_load_dwordx2 s[90:91], s[0:1], 112
s_waitcnt lgkmcnt(0)
s_add_u32 s8, s90, 151257088
s_addc_u32 s9, s91, 0
s_mov_b32 s10, 2621440
s_mov_b32 s11, 0x00020000
s_load_dwordx2 s[90:91], s[0:1], 112
s_waitcnt lgkmcnt(0)
s_add_u32 s12, s90, 153878528
s_addc_u32 s13, s91, 0
s_mov_b32 s14, 2621440
s_mov_b32 s15, 0x00020000
v_lshrrev_b32 v1, 6, v0
v_and_b32 v2, 63, v0
s_lshl_b32 s3, s2, 2
v_add_u32 v1, s3, v1
v_mul_u32_u24 v1, 1280, v1
v_lshl_add_u32 v1, v2, 2, v1
buffer_load_dword v30, v1, s[8:11], 0 offen offset:0
buffer_load_dword v31, v1, s[8:11], 0 offen offset:256
buffer_load_dword v32, v1, s[8:11], 0 offen offset:512
buffer_load_dword v33, v1, s[8:11], 0 offen offset:768
buffer_load_dword v34, v1, s[8:11], 0 offen offset:1024
s_waitcnt vmcnt(0)
v_lshlrev_b32 v10, 16, v30
v_and_b32 v11, 0xffff0000, v30
v_lshlrev_b32 v12, 16, v31
v_and_b32 v13, 0xffff0000, v31
v_lshlrev_b32 v14, 16, v32
v_and_b32 v15, 0xffff0000, v32
v_lshlrev_b32 v16, 16, v33
v_and_b32 v17, 0xffff0000, v33
v_lshlrev_b32 v18, 16, v34
v_and_b32 v19, 0xffff0000, v34
v_mov_b32 v20, 0
v_add_f32 v20, v20, v10
v_add_f32 v20, v20, v11
v_add_f32 v20, v20, v12
v_add_f32 v20, v20, v13
v_add_f32 v20, v20, v14
v_add_f32 v20, v20, v15
v_add_f32 v20, v20, v16
v_add_f32 v20, v20, v17
v_add_f32 v20, v20, v18
v_add_f32 v20, v20, v19
ds_swizzle_b32 v21, v20 offset:0x41f
s_waitcnt lgkmcnt(0)
v_add_f32 v20, v20, v21
ds_swizzle_b32 v21, v20 offset:0x81f
s_waitcnt lgkmcnt(0)
v_add_f32 v20, v20, v21
ds_swizzle_b32 v21, v20 offset:0x101f
s_waitcnt lgkmcnt(0)
v_add_f32 v20, v20, v21
ds_swizzle_b32 v21, v20 offset:0x201f
s_waitcnt lgkmcnt(0)
v_add_f32 v20, v20, v21
ds_swizzle_b32 v21, v20 offset:0x401f
s_waitcnt lgkmcnt(0)
v_add_f32 v20, v20, v21
s_nop 1
v_readlane_b32 s80, v20, 0
v_readlane_b32 s81, v20, 32
s_nop 3
v_mov_b32 v20, s80
v_add_f32 v20, s81, v20
v_mul_f32 v20, 0x3acccccd, v20
v_mov_b32 v22, 0
v_sub_f32 v23, v10, v20
v_fmac_f32 v22, v23, v23
v_sub_f32 v23, v11, v20
v_fmac_f32 v22, v23, v23
v_sub_f32 v23, v12, v20
v_fmac_f32 v22, v23, v23
v_sub_f32 v23, v13, v20
v_fmac_f32 v22, v23, v23
v_sub_f32 v23, v14, v20
v_fmac_f32 v22, v23, v23
v_sub_f32 v23, v15, v20
v_fmac_f32 v22, v23, v23
v_sub_f32 v23, v16, v20
v_fmac_f32 v22, v23, v23
v_sub_f32 v23, v17, v20
v_fmac_f32 v22, v23, v23
v_sub_f32 v23, v18, v20
v_fmac_f32 v22, v23, v23
v_sub_f32 v23, v19, v20
v_fmac_f32 v22, v23, v23
ds_swizzle_b32 v21, v22 offset:0x41f
s_waitcnt lgkmcnt(0)
v_add_f32 v22, v22, v21
ds_swizzle_b32 v21, v22 offset:0x81f
s_waitcnt lgkmcnt(0)
v_add_f32 v22, v22, v21
ds_swizzle_b32 v21, v22 offset:0x101f
s_waitcnt lgkmcnt(0)
v_add_f32 v22, v22, v21
ds_swizzle_b32 v21, v22 offset:0x201f
s_waitcnt lgkmcnt(0)
v_add_f32 v22, v22, v21
ds_swizzle_b32 v21, v22 offset:0x401f
s_waitcnt lgkmcnt(0)
v_add_f32 v22, v22, v21
s_nop 1
v_readlane_b32 s80, v22, 0
v_readlane_b32 s81, v22, 32
s_nop 3
v_mov_b32 v22, s80
v_add_f32 v22, s81, v22
v_mul_f32 v22, 0x3acccccd, v22
v_cvt_pk_bf16_f32 v21, v20, v20
v_lshlrev_b32 v20, 16, v21
v_cvt_pk_bf16_f32 v21, v22, v22
v_lshlrev_b32 v22, 16, v21
v_add_f32 v22, 0x3727c5ac, v22
v_cvt_pk_bf16_f32 v21, v22, v22
v_lshlrev_b32 v22, 16, v21
v_sqrt_f32 v22, v22
s_nop 0
v_cvt_pk_bf16_f32 v21, v22, v22
v_lshlrev_b32 v22, 16, v21
v_rcp_f32 v22, v22
s_nop 0
v_sub_f32 v10, v10, v20
v_cvt_pk_bf16_f32 v21, v10, v10
v_lshlrev_b32 v10, 16, v21
v_mul_f32 v10, v10, v22
v_cvt_pk_bf16_f32 v21, v10, v10
v_lshlrev_b32 v10, 16, v21
v_sub_f32 v11, v11, v20
v_cvt_pk_bf16_f32 v21, v11, v11
v_lshlrev_b32 v11, 16, v21
v_mul_f32 v11, v11, v22
v_cvt_pk_bf16_f32 v21, v11, v11
v_lshlrev_b32 v11, 16, v21
v_sub_f32 v12, v12, v20
v_cvt_pk_bf16_f32 v21, v12, v12
v_lshlrev_b32 v12, 16, v21
v_mul_f32 v12, v12, v22
v_cvt_pk_bf16_f32 v21, v12, v12
v_lshlrev_b32 v12, 16, v21
v_sub_f32 v13, v13, v20
v_cvt_pk_bf16_f32 v21, v13, v13
v_lshlrev_b32 v13, 16, v21
v_mul_f32 v13, v13, v22
v_cvt_pk_bf16_f32 v21, v13, v13
v_lshlrev_b32 v13, 16, v21
v_sub_f32 v14, v14, v20
v_cvt_pk_bf16_f32 v21, v14, v14
v_lshlrev_b32 v14, 16, v21
v_mul_f32 v14, v14, v22
v_cvt_pk_bf16_f32 v21, v14, v14
v_lshlrev_b32 v14, 16, v21
v_sub_f32 v15, v15, v20
v_cvt_pk_bf16_f32 v21, v15, v15
v_lshlrev_b32 v15, 16, v21
v_mul_f32 v15, v15, v22
v_cvt_pk_bf16_f32 v21, v15, v15
v_lshlrev_b32 v15, 16, v21
v_sub_f32 v16, v16, v20
v_cvt_pk_bf16_f32 v21, v16, v16
v_lshlrev_b32 v16, 16, v21
v_mul_f32 v16, v16, v22
v_cvt_pk_bf16_f32 v21, v16, v16
v_lshlrev_b32 v16, 16, v21
v_sub_f32 v17, v17, v20
v_cvt_pk_bf16_f32 v21, v17, v17
v_lshlrev_b32 v17, 16, v21
v_mul_f32 v17, v17, v22
v_cvt_pk_bf16_f32 v21, v17, v17
v_lshlrev_b32 v17, 16, v21
v_sub_f32 v18, v18, v20
v_cvt_pk_bf16_f32 v21, v18, v18
v_lshlrev_b32 v18, 16, v21
v_mul_f32 v18, v18, v22
v_cvt_pk_bf16_f32 v21, v18, v18
v_lshlrev_b32 v18, 16, v21
v_sub_f32 v19, v19, v20
v_cvt_pk_bf16_f32 v21, v19, v19
v_lshlrev_b32 v19, 16, v21
v_mul_f32 v19, v19, v22
v_cvt_pk_bf16_f32 v21, v19, v19
v_lshlrev_b32 v19, 16, v21
v_mov_b32 v20, 0
v_add_f32 v20, v20, v10
v_add_f32 v20, v20, v11
v_add_f32 v20, v20, v12
v_add_f32 v20, v20, v13
v_add_f32 v20, v20, v14
v_add_f32 v20, v20, v15
v_add_f32 v20, v20, v16
v_add_f32 v20, v20, v17
v_add_f32 v20, v20, v18
v_add_f32 v20, v20, v19
ds_swizzle_b32 v21, v20 offset:0x41f
s_waitcnt lgkmcnt(0)
v_add_f32 v20, v20, v21
ds_swizzle_b32 v21, v20 offset:0x81f
s_waitcnt lgkmcnt(0)
v_add_f32 v20, v20, v21
ds_swizzle_b32 v21, v20 offset:0x101f
s_waitcnt lgkmcnt(0)
v_add_f32 v20, v20, v21
ds_swizzle_b32 v21, v20 offset:0x201f
s_waitcnt lgkmcnt(0)
v_add_f32 v20, v20, v21
ds_swizzle_b32 v21, v20 offset:0x401f
s_waitcnt lgkmcnt(0)
v_add_f32 v20, v20, v21
s_nop 1
v_readlane_b32 s80, v20, 0
v_readlane_b32 s81, v20, 32
s_nop 3
v_mov_b32 v20, s80
v_add_f32 v20, s81, v20
v_mul_f32 v20, 0x3acccccd, v20
v_mov_b32 v22, 0
v_sub_f32 v23, v10, v20
v_fmac_f32 v22, v23, v23
v_sub_f32 v23, v11, v20
v_fmac_f32 v22, v23, v23
v_sub_f32 v23, v12, v20
v_fmac_f32 v22, v23, v23
v_sub_f32 v23, v13, v20
v_fmac_f32 v22, v23, v23
v_sub_f32 v23, v14, v20
v_fmac_f32 v22, v23, v23
v_sub_f32 v23, v15, v20
v_fmac_f32 v22, v23, v23
v_sub_f32 v23, v16, v20
v_fmac_f32 v22, v23, v23
v_sub_f32 v23, v17, v20
v_fmac_f32 v22, v23, v23
v_sub_f32 v23, v18, v20
v_fmac_f32 v22, v23, v23
v_sub_f32 v23, v19, v20
v_fmac_f32 v22, v23, v23
ds_swizzle_b32 v21, v22 offset:0x41f
s_waitcnt lgkmcnt(0)
v_add_f32 v22, v22, v21
ds_swizzle_b32 v21, v22 offset:0x81f
s_waitcnt lgkmcnt(0)
v_add_f32 v22, v22, v21
ds_swizzle_b32 v21, v22 offset:0x101f
s_waitcnt lgkmcnt(0)
v_add_f32 v22, v22, v21
ds_swizzle_b32 v21, v22 offset:0x201f
s_waitcnt lgkmcnt(0)
v_add_f32 v22, v22, v21
ds_swizzle_b32 v21, v22 offset:0x401f
s_waitcnt lgkmcnt(0)
v_add_f32 v22, v22, v21
s_nop 1
v_readlane_b32 s80, v22, 0
v_readlane_b32 s81, v22, 32
s_nop 3
v_mov_b32 v22, s80
v_add_f32 v22, s81, v22
v_mul_f32 v22, 0x3acccccd, v22
v_cvt_pk_bf16_f32 v21, v20, v20
v_lshlrev_b32 v20, 16, v21
v_cvt_pk_bf16_f32 v21, v22, v22
v_lshlrev_b32 v22, 16, v21
v_add_f32 v22, 0x3727c5ac, v22
v_cvt_pk_bf16_f32 v21, v22, v22
v_lshlrev_b32 v22, 16, v21
v_sqrt_f32 v22, v22
s_nop 0
v_cvt_pk_bf16_f32 v21, v22, v22
v_lshlrev_b32 v22, 16, v21
v_rcp_f32 v22, v22
s_nop 0
v_sub_f32 v10, v10, v20
v_cvt_pk_bf16_f32 v21, v10, v10
v_lshlrev_b32 v10, 16, v21
v_mul_f32 v10, v10, v22
v_cvt_pk_bf16_f32 v21, v10, v10
v_lshlrev_b32 v10, 16, v21
v_sub_f32 v11, v11, v20
v_cvt_pk_bf16_f32 v21, v11, v11
v_lshlrev_b32 v11, 16, v21
v_mul_f32 v11, v11, v22
v_cvt_pk_bf16_f32 v21, v11, v11
v_lshlrev_b32 v11, 16, v21
v_sub_f32 v12, v12, v20
v_cvt_pk_bf16_f32 v21, v12, v12
v_lshlrev_b32 v12, 16, v21
v_mul_f32 v12, v12, v22
v_cvt_pk_bf16_f32 v21, v12, v12
v_lshlrev_b32 v12, 16, v21
v_sub_f32 v13, v13, v20
v_cvt_pk_bf16_f32 v21, v13, v13
v_lshlrev_b32 v13, 16, v21
v_mul_f32 v13, v13, v22
v_cvt_pk_bf16_f32 v21, v13, v13
v_lshlrev_b32 v13, 16, v21
v_sub_f32 v14, v14, v20
v_cvt_pk_bf16_f32 v21, v14, v14
v_lshlrev_b32 v14, 16, v21
v_mul_f32 v14, v14, v22
v_cvt_pk_bf16_f32 v21, v14, v14
v_lshlrev_b32 v14, 16, v21
v_sub_f32 v15, v15, v20
v_cvt_pk_bf16_f32 v21, v15, v15
v_lshlrev_b32 v15, 16, v21
v_mul_f32 v15, v15, v22
v_cvt_pk_bf16_f32 v21, v15, v15
v_lshlrev_b32 v15, 16, v21
v_sub_f32 v16, v16, v20
v_cvt_pk_bf16_f32 v21, v16, v16
v_lshlrev_b32 v16, 16, v21
v_mul_f32 v16, v16, v22
v_cvt_pk_bf16_f32 v21, v16, v16
v_lshlrev_b32 v16, 16, v21
v_sub_f32 v17, v17, v20
v_cvt_pk_bf16_f32 v21, v17, v17
v_lshlrev_b32 v17, 16, v21
v_mul_f32 v17, v17, v22
v_cvt_pk_bf16_f32 v21, v17, v17
v_lshlrev_b32 v17, 16, v21
v_sub_f32 v18, v18, v20
v_cvt_pk_bf16_f32 v21, v18, v18
v_lshlrev_b32 v18, 16, v21
v_mul_f32 v18, v18, v22
v_cvt_pk_bf16_f32 v21, v18, v18
v_lshlrev_b32 v18, 16, v21
v_sub_f32 v19, v19, v20
v_cvt_pk_bf16_f32 v21, v19, v19
v_lshlrev_b32 v19, 16, v21
v_mul_f32 v19, v19, v22
v_cvt_pk_bf16_f32 v21, v19, v19
v_lshlrev_b32 v19, 16, v21
v_cvt_pk_bf16_f32 v30, v10, v11
buffer_store_dword v30, v1, s[12:15], 0 offen offset:0
v_cvt_pk_bf16_f32 v30, v12, v13
buffer_store_dword v30, v1, s[12:15], 0 offen offset:256
v_cvt_pk_bf16_f32 v30, v14, v15
buffer_store_dword v30, v1, s[12:15], 0 offen offset:512
v_cvt_pk_bf16_f32 v30, v16, v17
buffer_store_dword v30, v1, s[12:15], 0 offen offset:768
v_cvt_pk_bf16_f32 v30, v18, v19
buffer_store_dword v30, v1, s[12:15], 0 offen offset:1024
ln2_kernel_e:
s_endpgm
.p2align 8
g3_kernel:
s_cmp_ge_u32 s2, 768
s_cbranch_scc1 g3_kernel_e
s_load_dwordx2 s[90:91], s[0:1], 112
s_waitcnt lgkmcnt(0)
s_add_u32 s8, s90, 153878528
s_addc_u32 s9, s91, 0
s_mov_b32 s10, 2621440
s_mov_b32 s11, 0x00020000
s_load_dwordx2 s[90:91], s[0:1], 112
s_waitcnt lgkmcnt(0)
s_add_u32 s12, s90, 34078720
s_addc_u32 s13, s91, 0
s_mov_b32 s14, 1966080
s_mov_b32 s15, 0x00020000
s_and_b32 s24, s2, 31
s_lshr_b32 s25, s2, 5
s_mul_i32 s26, s24, 81920
s_mul_i32 s27, s25, 81920
v_add_u32 v2, 0, v0
v_lshrrev_b32 v3, 3, v2
v_and_b32 v4, 7, v2
v_mul_u32_u24 v5, 1280, v3
v_lshl_add_u32 v5, v4, 4, v5
v_add_u32 v128, s26, v5
v_add_u32 v132, s27, v5
v_mul_u32_u24 v5, 144, v3
v_lshl_add_u32 v136, v4, 4, v5
v_add_u32 v2, 256, v0
v_lshrrev_b32 v3, 3, v2
v_and_b32 v4, 7, v2
v_mul_u32_u24 v5, 1280, v3
v_lshl_add_u32 v5, v4, 4, v5
v_add_u32 v129, s26, v5
v_add_u32 v133, s27, v5
v_mul_u32_u24 v5, 144, v3
v_lshl_add_u32 v137, v4, 4, v5
v_lshrrev_b32 v2, 6, v0
v_and_b32 v3, 63, v0
v_lshrrev_b32 v4, 1, v2
v_and_b32 v5, 1, v2
v_and_b32 v6, 31, v3
v_lshrrev_b32 v7, 5, v3
v_mul_u32_u24 v140, 32, v4
v_add_u32 v140, v140, v6
v_mul_u32_u24 v140, 144, v140
v_lshl_add_u32 v140, v7, 4, v140
v_mul_u32_u24 v141, 32, v5
v_add_u32 v141, v141, v6
v_mul_u32_u24 v141, 144, v141
v_lshl_add_u32 v141, v7, 4, v141
v_add_u32 v141, 9216, v141
v_mov_b32 v64, 0
v_mov_b32 v65, 0
v_mov_b32 v66, 0
v_mov_b32 v67, 0
v_mov_b32 v68, 0
v_mov_b32 v69, 0
v_mov_b32 v70, 0
v_mov_b32 v71, 0
v_mov_b32 v72, 0
v_mov_b32 v73, 0
v_mov_b32 v74, 0
v_mov_b32 v75, 0
v_mov_b32 v76, 0
v_mov_b32 v77, 0
v_mov_b32 v78, 0
v_mov_b32 v79, 0
s_mov_b32 s28, 0
buffer_load_dwordx4 v[32:35], v128, s[8:11], s28 offen
buffer_load_dwordx4 v[48:51], v132, s[12:15], s28 offen
buffer_load_dwordx4 v[36:39], v129, s[8:11], s28 offen
buffer_load_dwordx4 v[52:55], v133, s[12:15], s28 offen
g3_kernel_l:
s_waitcnt vmcnt(0)
ds_write_b128 v136, v[32:35]
ds_write_b128 v136, v[48:51] offset:9216
ds_write_b128 v137, v[36:39]
ds_write_b128 v137, v[52:55] offset:9216
s_waitcnt lgkmcnt(0)
s_barrier
s_add_u32 s28, s28, 128
buffer_load_dwordx4 v[32:35], v128, s[8:11], s28 offen
buffer_load_dwordx4 v[48:51], v132, s[12:15], s28 offen
buffer_load_dwordx4 v[36:39], v129, s[8:11], s28 offen
buffer_load_dwordx4 v[52:55], v133, s[12:15], s28 offen
ds_read_b128 v[8:11], v140 offset:0
ds_read_b128 v[16:19], v141 offset:0
s_waitcnt lgkmcnt(0)
v_mfma_f32_32x32x16_bf16 v[64:79], v[8:11], v[16:19], v[64:79]
ds_read_b128 v[8:11], v140 offset:32
ds_read_b128 v[16:19], v141 offset:32
s_waitcnt lgkmcnt(0)
v_mfma_f32_32x32x16_bf16 v[64:79], v[8:11], v[16:19], v[64:79]
ds_read_b128 v[8:11], v140 offset:64
ds_read_b128 v[16:19], v141 offset:64
s_waitcnt lgkmcnt(0)
v_mfma_f32_32x32x16_bf16 v[64:79], v[8:11], v[16:19], v[64:79]
ds_read_b128 v[8:11], v140 offset:96
ds_read_b128 v[16:19], v141 offset:96
s_waitcnt lgkmcnt(0)
v_mfma_f32_32x32x16_bf16 v[64:79], v[8:11], v[16:19], v[64:79]
s_barrier
s_cmp_lt_u32 s28, 1280
s_cbranch_scc1 g3_kernel_l
s_nop 15
s_waitcnt vmcnt(0)
s_mul_i32 s26, s24, 64
s_mul_i32 s27, s25, 64
v_mul_u32_u24 v8, 32, v4
v_lshl_add_u32 v8, v7, 2, v8
v_add_u32 v8, s26, v8
v_mul_u32_u24 v9, 32, v5
v_add_u32 v9, v9, v6
v_add_u32 v9, s27, v9
s_load_dwordx2 s[90:91], s[0:1], 112
s_waitcnt lgkmcnt(0)
s_add_u32 s16, s90, 156499968
s_addc_u32 s17, s91, 0
s_mov_b32 s18, 6291456
s_mov_b32 s19, 0x00020000
s_load_dwordx2 s[90:91], s[0:1], 72
s_waitcnt lgkmcnt(0)
s_add_u32 s20, s90, 0
s_addc_u32 s21, s91, 0
s_mov_b32 s22, 3072
s_mov_b32 s23, 0x00020000
v_add_u32 v11, 0, v9
v_lshlrev_b32 v11, 1, v11
buffer_load_ushort v14, v11, s[20:23], 0 offen
s_waitcnt vmcnt(0)
v_lshlrev_b32 v14, 16, v14
v_add_u32 v10, 0, v8
v_mul_u32_u24 v10, 3072, v10
v_add_u32 v10, v10, v11
v_cvt_pk_bf16_f32 v12, v64, v64
v_lshlrev_b32 v64, 16, v12
v_add_f32 v64, v64, v14
v_cvt_pk_bf16_f32 v12, v64, v64
v_lshlrev_b32 v64, 16, v12
v_mul_f32 v15, v64, v64
v_mul_f32 v15, 0x3d372713, v15
v_add_f32 v15, 1.0, v15
v_mul_f32 v15, v15, v64
v_mul_f32 v15, 0xc0135761, v15
v_exp_f32 v15, v15
s_nop 0
v_add_f32 v15, 1.0, v15
v_rcp_f32 v15, v15
s_nop 0
v_mul_f32 v64, v64, v15
v_cvt_pk_bf16_f32 v12, v64, v64
buffer_store_short v12, v10, s[16:19], 0 offen
v_add_u32 v10, 1, v8
v_mul_u32_u24 v10, 3072, v10
v_add_u32 v10, v10, v11
v_cvt_pk_bf16_f32 v12, v65, v65
v_lshlrev_b32 v65, 16, v12
v_add_f32 v65, v65, v14
v_cvt_pk_bf16_f32 v12, v65, v65
v_lshlrev_b32 v65, 16, v12
v_mul_f32 v15, v65, v65
v_mul_f32 v15, 0x3d372713, v15
v_add_f32 v15, 1.0, v15
v_mul_f32 v15, v15, v65
v_mul_f32 v15, 0xc0135761, v15
v_exp_f32 v15, v15
s_nop 0
v_add_f32 v15, 1.0, v15
v_rcp_f32 v15, v15
s_nop 0
v_mul_f32 v65, v65, v15
v_cvt_pk_bf16_f32 v12, v65, v65
buffer_store_short v12, v10, s[16:19], 0 offen
v_add_u32 v10, 2, v8
v_mul_u32_u24 v10, 3072, v10
v_add_u32 v10, v10, v11
v_cvt_pk_bf16_f32 v12, v66, v66
v_lshlrev_b32 v66, 16, v12
v_add_f32 v66, v66, v14
v_cvt_pk_bf16_f32 v12, v66, v66
v_lshlrev_b32 v66, 16, v12
v_mul_f32 v15, v66, v66
v_mul_f32 v15, 0x3d372713, v15
v_add_f32 v15, 1.0, v15
v_mul_f32 v15, v15, v66
v_mul_f32 v15, 0xc0135761, v15
v_exp_f32 v15, v15
s_nop 0
v_add_f32 v15, 1.0, v15
v_rcp_f32 v15, v15
s_nop 0
v_mul_f32 v66, v66, v15
v_cvt_pk_bf16_f32 v12, v66, v66
buffer_store_short v12, v10, s[16:19], 0 offen
v_add_u32 v10, 3, v8
v_mul_u32_u24 v10, 3072, v10
v_add_u32 v10, v10, v11
v_cvt_pk_bf16_f32 v12, v67, v67
v_lshlrev_b32 v67, 16, v12
v_add_f32 v67, v67, v14
v_cvt_pk_bf16_f32 v12, v67, v67
v_lshlrev_b32 v67, 16, v12
v_mul_f32 v15, v67, v67
v_mul_f32 v15, 0x3d372713, v15
v_add_f32 v15, 1.0, v15
v_mul_f32 v15, v15, v67
v_mul_f32 v15, 0xc0135761, v15
v_exp_f32 v15, v15
s_nop 0
v_add_f32 v15, 1.0, v15
v_rcp_f32 v15, v15
s_nop 0
v_mul_f32 v67, v67, v15
v_cvt_pk_bf16_f32 v12, v67, v67
buffer_store_short v12, v10, s[16:19], 0 offen
v_add_u32 v10, 8, v8
v_mul_u32_u24 v10, 3072, v10
v_add_u32 v10, v10, v11
v_cvt_pk_bf16_f32 v12, v68, v68
v_lshlrev_b32 v68, 16, v12
v_add_f32 v68, v68, v14
v_cvt_pk_bf16_f32 v12, v68, v68
v_lshlrev_b32 v68, 16, v12
v_mul_f32 v15, v68, v68
v_mul_f32 v15, 0x3d372713, v15
v_add_f32 v15, 1.0, v15
v_mul_f32 v15, v15, v68
v_mul_f32 v15, 0xc0135761, v15
v_exp_f32 v15, v15
s_nop 0
v_add_f32 v15, 1.0, v15
v_rcp_f32 v15, v15
s_nop 0
v_mul_f32 v68, v68, v15
v_cvt_pk_bf16_f32 v12, v68, v68
buffer_store_short v12, v10, s[16:19], 0 offen
v_add_u32 v10, 9, v8
v_mul_u32_u24 v10, 3072, v10
v_add_u32 v10, v10, v11
v_cvt_pk_bf16_f32 v12, v69, v69
v_lshlrev_b32 v69, 16, v12
v_add_f32 v69, v69, v14
v_cvt_pk_bf16_f32 v12, v69, v69
v_lshlrev_b32 v69, 16, v12
v_mul_f32 v15, v69, v69
v_mul_f32 v15, 0x3d372713, v15
v_add_f32 v15, 1.0, v15
v_mul_f32 v15, v15, v69
v_mul_f32 v15, 0xc0135761, v15
v_exp_f32 v15, v15
s_nop 0
v_add_f32 v15, 1.0, v15
v_rcp_f32 v15, v15
s_nop 0
v_mul_f32 v69, v69, v15
v_cvt_pk_bf16_f32 v12, v69, v69
buffer_store_short v12, v10, s[16:19], 0 offen
v_add_u32 v10, 10, v8
v_mul_u32_u24 v10, 3072, v10
v_add_u32 v10, v10, v11
v_cvt_pk_bf16_f32 v12, v70, v70
v_lshlrev_b32 v70, 16, v12
v_add_f32 v70, v70, v14
v_cvt_pk_bf16_f32 v12, v70, v70
v_lshlrev_b32 v70, 16, v12
v_mul_f32 v15, v70, v70
v_mul_f32 v15, 0x3d372713, v15
v_add_f32 v15, 1.0, v15
v_mul_f32 v15, v15, v70
v_mul_f32 v15, 0xc0135761, v15
v_exp_f32 v15, v15
s_nop 0
v_add_f32 v15, 1.0, v15
v_rcp_f32 v15, v15
s_nop 0
v_mul_f32 v70, v70, v15
v_cvt_pk_bf16_f32 v12, v70, v70
buffer_store_short v12, v10, s[16:19], 0 offen
v_add_u32 v10, 11, v8
v_mul_u32_u24 v10, 3072, v10
v_add_u32 v10, v10, v11
v_cvt_pk_bf16_f32 v12, v71, v71
v_lshlrev_b32 v71, 16, v12
v_add_f32 v71, v71, v14
v_cvt_pk_bf16_f32 v12, v71, v71
v_lshlrev_b32 v71, 16, v12
v_mul_f32 v15, v71, v71
v_mul_f32 v15, 0x3d372713, v15
v_add_f32 v15, 1.0, v15
v_mul_f32 v15, v15, v71
v_mul_f32 v15, 0xc0135761, v15
v_exp_f32 v15, v15
s_nop 0
v_add_f32 v15, 1.0, v15
v_rcp_f32 v15, v15
s_nop 0
v_mul_f32 v71, v71, v15
v_cvt_pk_bf16_f32 v12, v71, v71
buffer_store_short v12, v10, s[16:19], 0 offen
v_add_u32 v10, 16, v8
v_mul_u32_u24 v10, 3072, v10
v_add_u32 v10, v10, v11
v_cvt_pk_bf16_f32 v12, v72, v72
v_lshlrev_b32 v72, 16, v12
v_add_f32 v72, v72, v14
v_cvt_pk_bf16_f32 v12, v72, v72
v_lshlrev_b32 v72, 16, v12
v_mul_f32 v15, v72, v72
v_mul_f32 v15, 0x3d372713, v15
v_add_f32 v15, 1.0, v15
v_mul_f32 v15, v15, v72
v_mul_f32 v15, 0xc0135761, v15
v_exp_f32 v15, v15
s_nop 0
v_add_f32 v15, 1.0, v15
v_rcp_f32 v15, v15
s_nop 0
v_mul_f32 v72, v72, v15
v_cvt_pk_bf16_f32 v12, v72, v72
buffer_store_short v12, v10, s[16:19], 0 offen
v_add_u32 v10, 17, v8
v_mul_u32_u24 v10, 3072, v10
v_add_u32 v10, v10, v11
v_cvt_pk_bf16_f32 v12, v73, v73
v_lshlrev_b32 v73, 16, v12
v_add_f32 v73, v73, v14
v_cvt_pk_bf16_f32 v12, v73, v73
v_lshlrev_b32 v73, 16, v12
v_mul_f32 v15, v73, v73
v_mul_f32 v15, 0x3d372713, v15
v_add_f32 v15, 1.0, v15
v_mul_f32 v15, v15, v73
v_mul_f32 v15, 0xc0135761, v15
v_exp_f32 v15, v15
s_nop 0
v_add_f32 v15, 1.0, v15
v_rcp_f32 v15, v15
s_nop 0
v_mul_f32 v73, v73, v15
v_cvt_pk_bf16_f32 v12, v73, v73
buffer_store_short v12, v10, s[16:19], 0 offen
v_add_u32 v10, 18, v8
v_mul_u32_u24 v10, 3072, v10
v_add_u32 v10, v10, v11
v_cvt_pk_bf16_f32 v12, v74, v74
v_lshlrev_b32 v74, 16, v12
v_add_f32 v74, v74, v14
v_cvt_pk_bf16_f32 v12, v74, v74
v_lshlrev_b32 v74, 16, v12
v_mul_f32 v15, v74, v74
v_mul_f32 v15, 0x3d372713, v15
v_add_f32 v15, 1.0, v15
v_mul_f32 v15, v15, v74
v_mul_f32 v15, 0xc0135761, v15
v_exp_f32 v15, v15
s_nop 0
v_add_f32 v15, 1.0, v15
v_rcp_f32 v15, v15
s_nop 0
v_mul_f32 v74, v74, v15
v_cvt_pk_bf16_f32 v12, v74, v74
buffer_store_short v12, v10, s[16:19], 0 offen
v_add_u32 v10, 19, v8
v_mul_u32_u24 v10, 3072, v10
v_add_u32 v10, v10, v11
v_cvt_pk_bf16_f32 v12, v75, v75
v_lshlrev_b32 v75, 16, v12
v_add_f32 v75, v75, v14
v_cvt_pk_bf16_f32 v12, v75, v75
v_lshlrev_b32 v75, 16, v12
v_mul_f32 v15, v75, v75
v_mul_f32 v15, 0x3d372713, v15
v_add_f32 v15, 1.0, v15
v_mul_f32 v15, v15, v75
v_mul_f32 v15, 0xc0135761, v15
v_exp_f32 v15, v15
s_nop 0
v_add_f32 v15, 1.0, v15
v_rcp_f32 v15, v15
s_nop 0
v_mul_f32 v75, v75, v15
v_cvt_pk_bf16_f32 v12, v75, v75
buffer_store_short v12, v10, s[16:19], 0 offen
v_add_u32 v10, 24, v8
v_mul_u32_u24 v10, 3072, v10
v_add_u32 v10, v10, v11
v_cvt_pk_bf16_f32 v12, v76, v76
v_lshlrev_b32 v76, 16, v12
v_add_f32 v76, v76, v14
v_cvt_pk_bf16_f32 v12, v76, v76
v_lshlrev_b32 v76, 16, v12
v_mul_f32 v15, v76, v76
v_mul_f32 v15, 0x3d372713, v15
v_add_f32 v15, 1.0, v15
v_mul_f32 v15, v15, v76
v_mul_f32 v15, 0xc0135761, v15
v_exp_f32 v15, v15
s_nop 0
v_add_f32 v15, 1.0, v15
v_rcp_f32 v15, v15
s_nop 0
v_mul_f32 v76, v76, v15
v_cvt_pk_bf16_f32 v12, v76, v76
buffer_store_short v12, v10, s[16:19], 0 offen
v_add_u32 v10, 25, v8
v_mul_u32_u24 v10, 3072, v10
v_add_u32 v10, v10, v11
v_cvt_pk_bf16_f32 v12, v77, v77
v_lshlrev_b32 v77, 16, v12
v_add_f32 v77, v77, v14
v_cvt_pk_bf16_f32 v12, v77, v77
v_lshlrev_b32 v77, 16, v12
v_mul_f32 v15, v77, v77
v_mul_f32 v15, 0x3d372713, v15
v_add_f32 v15, 1.0, v15
v_mul_f32 v15, v15, v77
v_mul_f32 v15, 0xc0135761, v15
v_exp_f32 v15, v15
s_nop 0
v_add_f32 v15, 1.0, v15
v_rcp_f32 v15, v15
s_nop 0
v_mul_f32 v77, v77, v15
v_cvt_pk_bf16_f32 v12, v77, v77
buffer_store_short v12, v10, s[16:19], 0 offen
v_add_u32 v10, 26, v8
v_mul_u32_u24 v10, 3072, v10
v_add_u32 v10, v10, v11
v_cvt_pk_bf16_f32 v12, v78, v78
v_lshlrev_b32 v78, 16, v12
v_add_f32 v78, v78, v14
v_cvt_pk_bf16_f32 v12, v78, v78
v_lshlrev_b32 v78, 16, v12
v_mul_f32 v15, v78, v78
v_mul_f32 v15, 0x3d372713, v15
v_add_f32 v15, 1.0, v15
v_mul_f32 v15, v15, v78
v_mul_f32 v15, 0xc0135761, v15
v_exp_f32 v15, v15
s_nop 0
v_add_f32 v15, 1.0, v15
v_rcp_f32 v15, v15
s_nop 0
v_mul_f32 v78, v78, v15
v_cvt_pk_bf16_f32 v12, v78, v78
buffer_store_short v12, v10, s[16:19], 0 offen
v_add_u32 v10, 27, v8
v_mul_u32_u24 v10, 3072, v10
v_add_u32 v10, v10, v11
v_cvt_pk_bf16_f32 v12, v79, v79
v_lshlrev_b32 v79, 16, v12
v_add_f32 v79, v79, v14
v_cvt_pk_bf16_f32 v12, v79, v79
v_lshlrev_b32 v79, 16, v12
v_mul_f32 v15, v79, v79
v_mul_f32 v15, 0x3d372713, v15
v_add_f32 v15, 1.0, v15
v_mul_f32 v15, v15, v79
v_mul_f32 v15, 0xc0135761, v15
v_exp_f32 v15, v15
s_nop 0
v_add_f32 v15, 1.0, v15
v_rcp_f32 v15, v15
s_nop 0
v_mul_f32 v79, v79, v15
v_cvt_pk_bf16_f32 v12, v79, v79
buffer_store_short v12, v10, s[16:19], 0 offen
g3_kernel_e:
s_endpgm
.p2align 8
g4_kernel:
s_cmp_ge_u32 s2, 320
s_cbranch_scc1 g4_kernel_e
s_load_dwordx2 s[90:91], s[0:1], 112
s_waitcnt lgkmcnt(0)
s_add_u32 s8, s90, 156499968
s_addc_u32 s9, s91, 0
s_mov_b32 s10, 6291456
s_mov_b32 s11, 0x00020000
s_load_dwordx2 s[90:91], s[0:1], 112
s_waitcnt lgkmcnt(0)
s_add_u32 s12, s90, 36044800
s_addc_u32 s13, s91, 0
s_mov_b32 s14, 1966080
s_mov_b32 s15, 0x00020000
s_and_b32 s24, s2, 31
s_lshr_b32 s25, s2, 5
s_mul_i32 s26, s24, 196608
s_mul_i32 s27, s25, 196608
v_add_u32 v2, 0, v0
v_lshrrev_b32 v3, 3, v2
v_and_b32 v4, 7, v2
v_mul_u32_u24 v5, 3072, v3
v_lshl_add_u32 v5, v4, 4, v5
v_add_u32 v128, s26, v5
v_add_u32 v132, s27, v5
v_mul_u32_u24 v5, 144, v3
v_lshl_add_u32 v136, v4, 4, v5
v_add_u32 v2, 256, v0
v_lshrrev_b32 v3, 3, v2
v_and_b32 v4, 7, v2
v_mul_u32_u24 v5, 3072, v3
v_lshl_add_u32 v5, v4, 4, v5
v_add_u32 v129, s26, v5
v_add_u32 v133, s27, v5
v_mul_u32_u24 v5, 144, v3
v_lshl_add_u32 v137, v4, 4, v5
v_lshrrev_b32 v2, 6, v0
v_and_b32 v3, 63, v0
v_lshrrev_b32 v4, 1, v2
v_and_b32 v5, 1, v2
v_and_b32 v6, 31, v3
v_lshrrev_b32 v7, 5, v3
v_mul_u32_u24 v140, 32, v4
v_add_u32 v140, v140, v6
v_mul_u32_u24 v140, 144, v140
v_lshl_add_u32 v140, v7, 4, v140
v_mul_u32_u24 v141, 32, v5
v_add_u32 v141, v141, v6
v_mul_u32_u24 v141, 144, v141
v_lshl_add_u32 v141, v7, 4, v141
v_add_u32 v141, 9216, v141
v_mov_b32 v64, 0
v_mov_b32 v65, 0
v_mov_b32 v66, 0
v_mov_b32 v67, 0
v_mov_b32 v68, 0
v_mov_b32 v69, 0
v_mov_b32 v70, 0
v_mov_b32 v71, 0
v_mov_b32 v72, 0
v_mov_b32 v73, 0
v_mov_b32 v74, 0
v_mov_b32 v75, 0
v_mov_b32 v76, 0
v_mov_b32 v77, 0
v_mov_b32 v78, 0
v_mov_b32 v79, 0
s_mov_b32 s28, 0
buffer_load_dwordx4 v[32:35], v128, s[8:11], s28 offen
buffer_load_dwordx4 v[48:51], v132, s[12:15], s28 offen
buffer_load_dwordx4 v[36:39], v129, s[8:11], s28 offen
buffer_load_dwordx4 v[52:55], v133, s[12:15], s28 offen
g4_kernel_l:
s_waitcnt vmcnt(0)
ds_write_b128 v136, v[32:35]
ds_write_b128 v136, v[48:51] offset:9216
ds_write_b128 v137, v[36:39]
ds_write_b128 v137, v[52:55] offset:9216
s_waitcnt lgkmcnt(0)
s_barrier
s_add_u32 s28, s28, 128
buffer_load_dwordx4 v[32:35], v128, s[8:11], s28 offen
buffer_load_dwordx4 v[48:51], v132, s[12:15], s28 offen
buffer_load_dwordx4 v[36:39], v129, s[8:11], s28 offen
buffer_load_dwordx4 v[52:55], v133, s[12:15], s28 offen
ds_read_b128 v[8:11], v140 offset:0
ds_read_b128 v[16:19], v141 offset:0
s_waitcnt lgkmcnt(0)
v_mfma_f32_32x32x16_bf16 v[64:79], v[8:11], v[16:19], v[64:79]
ds_read_b128 v[8:11], v140 offset:32
ds_read_b128 v[16:19], v141 offset:32
s_waitcnt lgkmcnt(0)
v_mfma_f32_32x32x16_bf16 v[64:79], v[8:11], v[16:19], v[64:79]
ds_read_b128 v[8:11], v140 offset:64
ds_read_b128 v[16:19], v141 offset:64
s_waitcnt lgkmcnt(0)
v_mfma_f32_32x32x16_bf16 v[64:79], v[8:11], v[16:19], v[64:79]
ds_read_b128 v[8:11], v140 offset:96
ds_read_b128 v[16:19], v141 offset:96
s_waitcnt lgkmcnt(0)
v_mfma_f32_32x32x16_bf16 v[64:79], v[8:11], v[16:19], v[64:79]
s_barrier
s_cmp_lt_u32 s28, 3072
s_cbranch_scc1 g4_kernel_l
s_nop 15
s_waitcnt vmcnt(0)
s_mul_i32 s26, s24, 64
s_mul_i32 s27, s25, 64
v_mul_u32_u24 v8, 32, v4
v_lshl_add_u32 v8, v7, 2, v8
v_add_u32 v8, s26, v8
v_mul_u32_u24 v9, 32, v5
v_add_u32 v9, v9, v6
v_add_u32 v9, s27, v9
s_load_dwordx2 s[90:91], s[0:1], 96
s_waitcnt lgkmcnt(0)
s_add_u32 s16, s90, 0
s_addc_u32 s17, s91, 0
s_mov_b32 s18, 2621440
s_mov_b32 s19, 0x00020000
s_load_dwordx2 s[90:91], s[0:1], 88
s_waitcnt lgkmcnt(0)
s_add_u32 s20, s90, 0
s_addc_u32 s21, s91, 0
s_mov_b32 s22, 1280
s_mov_b32 s23, 0x00020000
s_load_dwordx2 s[90:91], s[0:1], 112
s_waitcnt lgkmcnt(0)
s_add_u32 s32, s90, 151257088
s_addc_u32 s33, s91, 0
s_mov_b32 s34, 2621440
s_mov_b32 s35, 0x00020000
v_add_u32 v11, 0, v9
v_lshlrev_b32 v11, 1, v11
buffer_load_ushort v14, v11, s[20:23], 0 offen
s_waitcnt vmcnt(0)
v_lshlrev_b32 v14, 16, v14
v_add_u32 v10, 0, v8
v_mul_u32_u24 v10, 1280, v10
v_add_u32 v10, v10, v11
v_cvt_pk_bf16_f32 v12, v64, v64
v_lshlrev_b32 v64, 16, v12
v_add_f32 v64, v64, v14
v_cvt_pk_bf16_f32 v12, v64, v64
v_lshlrev_b32 v64, 16, v12
buffer_load_ushort v15, v10, s[32:35], 0 offen
s_waitcnt vmcnt(0)
v_lshlrev_b32 v15, 16, v15
v_add_f32 v64, v64, v15
v_cvt_pk_bf16_f32 v12, v64, v64
buffer_store_short v12, v10, s[16:19], 0 offen
v_add_u32 v10, 1, v8
v_mul_u32_u24 v10, 1280, v10
v_add_u32 v10, v10, v11
v_cvt_pk_bf16_f32 v12, v65, v65
v_lshlrev_b32 v65, 16, v12
v_add_f32 v65, v65, v14
v_cvt_pk_bf16_f32 v12, v65, v65
v_lshlrev_b32 v65, 16, v12
buffer_load_ushort v15, v10, s[32:35], 0 offen
s_waitcnt vmcnt(0)
v_lshlrev_b32 v15, 16, v15
v_add_f32 v65, v65, v15
v_cvt_pk_bf16_f32 v12, v65, v65
buffer_store_short v12, v10, s[16:19], 0 offen
v_add_u32 v10, 2, v8
v_mul_u32_u24 v10, 1280, v10
v_add_u32 v10, v10, v11
v_cvt_pk_bf16_f32 v12, v66, v66
v_lshlrev_b32 v66, 16, v12
v_add_f32 v66, v66, v14
v_cvt_pk_bf16_f32 v12, v66, v66
v_lshlrev_b32 v66, 16, v12
buffer_load_ushort v15, v10, s[32:35], 0 offen
s_waitcnt vmcnt(0)
v_lshlrev_b32 v15, 16, v15
v_add_f32 v66, v66, v15
v_cvt_pk_bf16_f32 v12, v66, v66
buffer_store_short v12, v10, s[16:19], 0 offen
v_add_u32 v10, 3, v8
v_mul_u32_u24 v10, 1280, v10
v_add_u32 v10, v10, v11
v_cvt_pk_bf16_f32 v12, v67, v67
v_lshlrev_b32 v67, 16, v12
v_add_f32 v67, v67, v14
v_cvt_pk_bf16_f32 v12, v67, v67
v_lshlrev_b32 v67, 16, v12
buffer_load_ushort v15, v10, s[32:35], 0 offen
s_waitcnt vmcnt(0)
v_lshlrev_b32 v15, 16, v15
v_add_f32 v67, v67, v15
v_cvt_pk_bf16_f32 v12, v67, v67
buffer_store_short v12, v10, s[16:19], 0 offen
v_add_u32 v10, 8, v8
v_mul_u32_u24 v10, 1280, v10
v_add_u32 v10, v10, v11
v_cvt_pk_bf16_f32 v12, v68, v68
v_lshlrev_b32 v68, 16, v12
v_add_f32 v68, v68, v14
v_cvt_pk_bf16_f32 v12, v68, v68
v_lshlrev_b32 v68, 16, v12
buffer_load_ushort v15, v10, s[32:35], 0 offen
s_waitcnt vmcnt(0)
v_lshlrev_b32 v15, 16, v15
v_add_f32 v68, v68, v15
v_cvt_pk_bf16_f32 v12, v68, v68
buffer_store_short v12, v10, s[16:19], 0 offen
v_add_u32 v10, 9, v8
v_mul_u32_u24 v10, 1280, v10
v_add_u32 v10, v10, v11
v_cvt_pk_bf16_f32 v12, v69, v69
v_lshlrev_b32 v69, 16, v12
v_add_f32 v69, v69, v14
v_cvt_pk_bf16_f32 v12, v69, v69
v_lshlrev_b32 v69, 16, v12
buffer_load_ushort v15, v10, s[32:35], 0 offen
s_waitcnt vmcnt(0)
v_lshlrev_b32 v15, 16, v15
v_add_f32 v69, v69, v15
v_cvt_pk_bf16_f32 v12, v69, v69
buffer_store_short v12, v10, s[16:19], 0 offen
v_add_u32 v10, 10, v8
v_mul_u32_u24 v10, 1280, v10
v_add_u32 v10, v10, v11
v_cvt_pk_bf16_f32 v12, v70, v70
v_lshlrev_b32 v70, 16, v12
v_add_f32 v70, v70, v14
v_cvt_pk_bf16_f32 v12, v70, v70
v_lshlrev_b32 v70, 16, v12
buffer_load_ushort v15, v10, s[32:35], 0 offen
s_waitcnt vmcnt(0)
v_lshlrev_b32 v15, 16, v15
v_add_f32 v70, v70, v15
v_cvt_pk_bf16_f32 v12, v70, v70
buffer_store_short v12, v10, s[16:19], 0 offen
v_add_u32 v10, 11, v8
v_mul_u32_u24 v10, 1280, v10
v_add_u32 v10, v10, v11
v_cvt_pk_bf16_f32 v12, v71, v71
v_lshlrev_b32 v71, 16, v12
v_add_f32 v71, v71, v14
v_cvt_pk_bf16_f32 v12, v71, v71
v_lshlrev_b32 v71, 16, v12
buffer_load_ushort v15, v10, s[32:35], 0 offen
s_waitcnt vmcnt(0)
v_lshlrev_b32 v15, 16, v15
v_add_f32 v71, v71, v15
v_cvt_pk_bf16_f32 v12, v71, v71
buffer_store_short v12, v10, s[16:19], 0 offen
v_add_u32 v10, 16, v8
v_mul_u32_u24 v10, 1280, v10
v_add_u32 v10, v10, v11
v_cvt_pk_bf16_f32 v12, v72, v72
v_lshlrev_b32 v72, 16, v12
v_add_f32 v72, v72, v14
v_cvt_pk_bf16_f32 v12, v72, v72
v_lshlrev_b32 v72, 16, v12
buffer_load_ushort v15, v10, s[32:35], 0 offen
s_waitcnt vmcnt(0)
v_lshlrev_b32 v15, 16, v15
v_add_f32 v72, v72, v15
v_cvt_pk_bf16_f32 v12, v72, v72
buffer_store_short v12, v10, s[16:19], 0 offen
v_add_u32 v10, 17, v8
v_mul_u32_u24 v10, 1280, v10
v_add_u32 v10, v10, v11
v_cvt_pk_bf16_f32 v12, v73, v73
v_lshlrev_b32 v73, 16, v12
v_add_f32 v73, v73, v14
v_cvt_pk_bf16_f32 v12, v73, v73
v_lshlrev_b32 v73, 16, v12
buffer_load_ushort v15, v10, s[32:35], 0 offen
s_waitcnt vmcnt(0)
v_lshlrev_b32 v15, 16, v15
v_add_f32 v73, v73, v15
v_cvt_pk_bf16_f32 v12, v73, v73
buffer_store_short v12, v10, s[16:19], 0 offen
v_add_u32 v10, 18, v8
v_mul_u32_u24 v10, 1280, v10
v_add_u32 v10, v10, v11
v_cvt_pk_bf16_f32 v12, v74, v74
v_lshlrev_b32 v74, 16, v12
v_add_f32 v74, v74, v14
v_cvt_pk_bf16_f32 v12, v74, v74
v_lshlrev_b32 v74, 16, v12
buffer_load_ushort v15, v10, s[32:35], 0 offen
s_waitcnt vmcnt(0)
v_lshlrev_b32 v15, 16, v15
v_add_f32 v74, v74, v15
v_cvt_pk_bf16_f32 v12, v74, v74
buffer_store_short v12, v10, s[16:19], 0 offen
v_add_u32 v10, 19, v8
v_mul_u32_u24 v10, 1280, v10
v_add_u32 v10, v10, v11
v_cvt_pk_bf16_f32 v12, v75, v75
v_lshlrev_b32 v75, 16, v12
v_add_f32 v75, v75, v14
v_cvt_pk_bf16_f32 v12, v75, v75
v_lshlrev_b32 v75, 16, v12
buffer_load_ushort v15, v10, s[32:35], 0 offen
s_waitcnt vmcnt(0)
v_lshlrev_b32 v15, 16, v15
v_add_f32 v75, v75, v15
v_cvt_pk_bf16_f32 v12, v75, v75
buffer_store_short v12, v10, s[16:19], 0 offen
v_add_u32 v10, 24, v8
v_mul_u32_u24 v10, 1280, v10
v_add_u32 v10, v10, v11
v_cvt_pk_bf16_f32 v12, v76, v76
v_lshlrev_b32 v76, 16, v12
v_add_f32 v76, v76, v14
v_cvt_pk_bf16_f32 v12, v76, v76
v_lshlrev_b32 v76, 16, v12
buffer_load_ushort v15, v10, s[32:35], 0 offen
s_waitcnt vmcnt(0)
v_lshlrev_b32 v15, 16, v15
v_add_f32 v76, v76, v15
v_cvt_pk_bf16_f32 v12, v76, v76
buffer_store_short v12, v10, s[16:19], 0 offen
v_add_u32 v10, 25, v8
v_mul_u32_u24 v10, 1280, v10
v_add_u32 v10, v10, v11
v_cvt_pk_bf16_f32 v12, v77, v77
v_lshlrev_b32 v77, 16, v12
v_add_f32 v77, v77, v14
v_cvt_pk_bf16_f32 v12, v77, v77
v_lshlrev_b32 v77, 16, v12
buffer_load_ushort v15, v10, s[32:35], 0 offen
s_waitcnt vmcnt(0)
v_lshlrev_b32 v15, 16, v15
v_add_f32 v77, v77, v15
v_cvt_pk_bf16_f32 v12, v77, v77
buffer_store_short v12, v10, s[16:19], 0 offen
v_add_u32 v10, 26, v8
v_mul_u32_u24 v10, 1280, v10
v_add_u32 v10, v10, v11
v_cvt_pk_bf16_f32 v12, v78, v78
v_lshlrev_b32 v78, 16, v12
v_add_f32 v78, v78, v14
v_cvt_pk_bf16_f32 v12, v78, v78
v_lshlrev_b32 v78, 16, v12
buffer_load_ushort v15, v10, s[32:35], 0 offen
s_waitcnt vmcnt(0)
v_lshlrev_b32 v15, 16, v15
v_add_f32 v78, v78, v15
v_cvt_pk_bf16_f32 v12, v78, v78
buffer_store_short v12, v10, s[16:19], 0 offen
v_add_u32 v10, 27, v8
v_mul_u32_u24 v10, 1280, v10
v_add_u32 v10, v10, v11
v_cvt_pk_bf16_f32 v12, v79, v79
v_lshlrev_b32 v79, 16, v12
v_add_f32 v79, v79, v14
v_cvt_pk_bf16_f32 v12, v79, v79
v_lshlrev_b32 v79, 16, v12
buffer_load_ushort v15, v10, s[32:35], 0 offen
s_waitcnt vmcnt(0)
v_lshlrev_b32 v15, 16, v15
v_add_f32 v79, v79, v15
v_cvt_pk_bf16_f32 v12, v79, v79
buffer_store_short v12, v10, s[16:19], 0 offen
g4_kernel_e:
s_endpgm
.section .rodata,"a"
.p2align 6
.amdhsa_kernel clr_kernel
  .amdhsa_next_free_vgpr 16
  .amdhsa_next_free_sgpr 96
  .amdhsa_accum_offset 16
  .amdhsa_group_segment_fixed_size 0
  .amdhsa_kernarg_size 120
  .amdhsa_user_sgpr_count 2
  .amdhsa_user_sgpr_kernarg_segment_ptr 1
  .amdhsa_system_sgpr_workgroup_id_x 1
.end_amdhsa_kernel
.p2align 6
.amdhsa_kernel ln1_kernel
  .amdhsa_next_free_vgpr 40
  .amdhsa_next_free_sgpr 96
  .amdhsa_accum_offset 40
  .amdhsa_group_segment_fixed_size 0
  .amdhsa_kernarg_size 120
  .amdhsa_user_sgpr_count 2
  .amdhsa_user_sgpr_kernarg_segment_ptr 1
  .amdhsa_system_sgpr_workgroup_id_x 1
.end_amdhsa_kernel
.p2align 6
.amdhsa_kernel tq_kernel
  .amdhsa_next_free_vgpr 64
  .amdhsa_next_free_sgpr 96
  .amdhsa_accum_offset 64
  .amdhsa_group_segment_fixed_size 0
  .amdhsa_kernarg_size 120
  .amdhsa_user_sgpr_count 2
  .amdhsa_user_sgpr_kernarg_segment_ptr 1
  .amdhsa_system_sgpr_workgroup_id_x 1
.end_amdhsa_kernel
.p2align 6
.amdhsa_kernel tk_kernel
  .amdhsa_next_free_vgpr 64
  .amdhsa_next_free_sgpr 96
  .amdhsa_accum_offset 64
  .amdhsa_group_segment_fixed_size 0
  .amdhsa_kernarg_size 120
  .amdhsa_user_sgpr_count 2
  .amdhsa_user_sgpr_kernarg_segment_ptr 1
  .amdhsa_system_sgpr_workgroup_id_x 1
.end_amdhsa_kernel
.p2align 6
.amdhsa_kernel tv_kernel
  .amdhsa_next_free_vgpr 64
  .amdhsa_next_free_sgpr 96
  .amdhsa_accum_offset 64
  .amdhsa_group_segment_fixed_size 0
  .amdhsa_kernarg_size 120
  .amdhsa_user_sgpr_count 2
  .amdhsa_user_sgpr_kernarg_segment_ptr 1
  .amdhsa_system_sgpr_workgroup_id_x 1
.end_amdhsa_kernel
.p2align 6
.amdhsa_kernel to_kernel
  .amdhsa_next_free_vgpr 64
  .amdhsa_next_free_sgpr 96
  .amdhsa_accum_offset 64
  .amdhsa_group_segment_fixed_size 0
  .amdhsa_kernarg_size 120
  .amdhsa_user_sgpr_count 2
  .amdhsa_user_sgpr_kernarg_segment_ptr 1
  .amdhsa_system_sgpr_workgroup_id_x 1
.end_amdhsa_kernel
.p2align 6
.amdhsa_kernel t1_kernel
  .amdhsa_next_free_vgpr 64
  .amdhsa_next_free_sgpr 96
  .amdhsa_accum_offset 64
  .amdhsa_group_segment_fixed_size 0
  .amdhsa_kernarg_size 120
  .amdhsa_user_sgpr_count 2
  .amdhsa_user_sgpr_kernarg_segment_ptr 1
  .amdhsa_system_sgpr_workgroup_id_x 1
.end_amdhsa_kernel
.p2align 6
.amdhsa_kernel t2_kernel
  .amdhsa_next_free_vgpr 64
  .amdhsa_next_free_sgpr 96
  .amdhsa_accum_offset 64
  .amdhsa_group_segment_fixed_size 0
  .amdhsa_kernarg_size 120
  .amdhsa_user_sgpr_count 2
  .amdhsa_user_sgpr_kernarg_segment_ptr 1
  .amdhsa_system_sgpr_workgroup_id_x 1
.end_amdhsa_kernel
.p2align 6
.amdhsa_kernel g1_kernel
  .amdhsa_next_free_vgpr 144
  .amdhsa_next_free_sgpr 96
  .amdhsa_accum_offset 144
  .amdhsa_group_segment_fixed_size 0
  .amdhsa_kernarg_size 120
  .amdhsa_user_sgpr_count 2
  .amdhsa_user_sgpr_kernarg_segment_ptr 1
  .amdhsa_system_sgpr_workgroup_id_x 1
.end_amdhsa_kernel
.p2align 6
.amdhsa_kernel ch_kernel
  .amdhsa_next_free_vgpr 388
  .amdhsa_next_free_sgpr 96
  .amdhsa_accum_offset 148
  .amdhsa_group_segment_fixed_size 0
  .amdhsa_kernarg_size 120
  .amdhsa_user_sgpr_count 2
  .amdhsa_user_sgpr_kernarg_segment_ptr 1
  .amdhsa_system_sgpr_workgroup_id_x 1
.end_amdhsa_kernel
.p2align 6
.amdhsa_kernel at_kernel
  .amdhsa_next_free_vgpr 112
  .amdhsa_next_free_sgpr 96
  .amdhsa_accum_offset 112
  .amdhsa_group_segment_fixed_size 0
  .amdhsa_kernarg_size 120
  .amdhsa_user_sgpr_count 2
  .amdhsa_user_sgpr_kernarg_segment_ptr 1
  .amdhsa_system_sgpr_workgroup_id_x 1
.end_amdhsa_kernel
.p2align 6
.amdhsa_kernel g2_kernel
  .amdhsa_next_free_vgpr 144
  .amdhsa_next_free_sgpr 96
  .amdhsa_accum_offset 144
  .amdhsa_group_segment_fixed_size 0
  .amdhsa_kernarg_size 120
  .amdhsa_user_sgpr_count 2
  .amdhsa_user_sgpr_kernarg_segment_ptr 1
  .amdhsa_system_sgpr_workgroup_id_x 1
.end_amdhsa_kernel
.p2align 6
.amdhsa_kernel ln2_kernel
  .amdhsa_next_free_vgpr 40
  .amdhsa_next_free_sgpr 96
  .amdhsa_accum_offset 40
  .amdhsa_group_segment_fixed_size 0
  .amdhsa_kernarg_size 120
  .amdhsa_user_sgpr_count 2
  .amdhsa_user_sgpr_kernarg_segment_ptr 1
  .amdhsa_system_sgpr_workgroup_id_x 1
.end_amdhsa_kernel
.p2align 6
.amdhsa_kernel g3_kernel
  .amdhsa_next_free_vgpr 144
  .amdhsa_next_free_sgpr 96
  .amdhsa_accum_offset 144
  .amdhsa_group_segment_fixed_size 0
  .amdhsa_kernarg_size 120
  .amdhsa_user_sgpr_count 2
  .amdhsa_user_sgpr_kernarg_segment_ptr 1
  .amdhsa_system_sgpr_workgroup_id_x 1
.end_amdhsa_kernel
.p2align 6
.amdhsa_kernel g4_kernel
  .amdhsa_next_free_vgpr 144
  .amdhsa_next_free_sgpr 96
  .amdhsa_accum_offset 144
  .amdhsa_group_segment_fixed_size 0
  .amdhsa_kernarg_size 120
  .amdhsa_user_sgpr_count 2
  .amdhsa_user_sgpr_kernarg_segment_ptr 1
  .amdhsa_system_sgpr_workgroup_id_x 1
.end_amdhsa_kernel
```
